```python
import torch

def _softmax(x, axis=-1):
    return torch.softmax(x, dim=axis)

def _gelu(x):
    return torch.nn.functional.gelu(x, approximate='tanh')

def _silu(x):
    return torch.nn.functional.silu(x)

def _sigmoid(x):
    return torch.sigmoid(x)

def _layernorm(x, axis=-1, eps=1e-05):
    m = x.mean(dim=axis, keepdim=True)
    v = x.var(dim=axis, keepdim=True, unbiased=False)
    return (x - m) / torch.sqrt(v + eps)

def _scatter_add(tgt, idx, src, axis=0):
    return tgt.clone().index_add_(axis, idx, src)

def _segment_sum(src, seg, n):
    out = torch.zeros((n,) + src.shape[1:], dtype=src.dtype)
    return out.index_add_(0, seg, src)

def _pad(x, pw):
    flat = tuple((v for pair in reversed(pw) for v in pair))
    return torch.nn.functional.pad(x, flat)
kernel_name = 'parallel_sum__mha_block__mixer_gmlp__prompt'

def setup_inputs():

    _w = lambda a: (lambda t: t.to(torch.bfloat16) if t.is_floating_point() else t)(torch.as_tensor(a))

    def _A_setup():
        B, S, D, H = (1, 2048, 512, 32)
        return {'x': _w((lambda *s: torch.randn(*s, dtype=torch.bfloat16) * 0.05)(B, S, D)), 'wqkv': _w((lambda *s: torch.randn(*s, dtype=torch.bfloat16) * 0.2)(D, 3 * D)), 'wo': _w((lambda *s: torch.randn(*s, dtype=torch.bfloat16) * 0.2)(D, D))}
    _A_in = _A_setup()

    def _B_setup():
        B, S, D, F = (1, 2048, 512, 1792)
        Fh = F // 2
        return {'x': _w((lambda *s: torch.randn(*s, dtype=torch.bfloat16) * 0.05)(B, S, D)), 'w_in': _w((lambda *s: torch.randn(*s, dtype=torch.bfloat16) * 0.8)(D, 2 * Fh)), 'w_sp': _w(0.01 * (lambda *s: torch.randn(*s, dtype=torch.bfloat16) * 0.8)(S, S)), 'b_sp': _w(1.0 + 0.01 * (lambda *s: torch.randn(*s, dtype=torch.bfloat16) * 0.2)(S)), 'w_out': _w((lambda *s: torch.randn(*s, dtype=torch.bfloat16) * 0.2)(Fh, D))}
    _B_in = _B_setup()
    return {'A_x': _A_in['x'], 'A_wqkv': _A_in['wqkv'], 'A_wo': _A_in['wo'], 'B_x': _B_in['x'], 'B_w_in': _B_in['w_in'], 'B_w_sp': _B_in['w_sp'], 'B_b_sp': _B_in['b_sp'], 'B_w_out': _B_in['w_out']}

def reference(A_x, A_wqkv, A_wo, B_x, B_w_in, B_w_sp, B_b_sp, B_w_out):

    def _A_ref(x, wqkv, wo):
        B, S, D = x.shape
        H = 32
        Dh = D // H
        qkv = (lambda x, *d: x.permute(*d))((x @ wqkv).reshape(B, S, 3, H, Dh), 2, 0, 3, 1, 4)
        q, k, v = (qkv[0], qkv[1], qkv[2])
        scores = torch.einsum('bhqd,bhkd->bhqk', q, k) * Dh ** (-0.5)
        p = _softmax(scores, axis=-1)
        o = torch.einsum('bhqk,bhkd->bhqd', p, v)
        return (lambda x, *d: x.permute(*d))(o, 0, 2, 1, 3).reshape(B, S, D) @ wo

    def _B_ref(x, w_in, w_sp, b_sp, w_out):
        B, S, D = x.shape
        F = w_in.shape[-1]
        Fh = F // 2
        z = _gelu(torch.einsum('bsd,df->bsf', x, w_in))
        z1 = z[..., :Fh].clone()
        z2 = _layernorm(z[..., Fh:], axis=-1)
        g = torch.einsum('ts,bsf->btf', w_sp, z2) + b_sp[None, :, None]
        return torch.einsum('bsf,fd->bsd', z1 * g, w_out)
    x = A_x
    xn = _layernorm(x, axis=-1)
    return x + _A_ref(xn, A_wqkv, A_wo) + _B_ref(xn, B_w_in, B_w_sp, B_b_sp, B_w_out)
```

```asm
; @launch grid=(256,1,1) block=(512,1,1) lds=163840
.amdgcn_target "amdgcn-amd-amdhsa--gfx950"
.text
.globl parallel_sum__mha_block__mixer_gmlp__prompt_kernel
.p2align 8
.type parallel_sum__mha_block__mixer_gmlp__prompt_kernel,@function
parallel_sum__mha_block__mixer_gmlp__prompt_kernel:
    s_cmp_ge_u32 s2, 256
    s_cbranch_scc0 P1_go
    s_endpgm
P1_go:
    s_load_dwordx2 s[4:5], s[0:1], 80
    s_load_dwordx4 s[44:47], s[0:1], 0
    s_load_dwordx2 s[28:29], s[0:1], 32
    v_lshrrev_b32 v1, 6, v0
    v_and_b32 v0, 63, v0
    v_readfirstlane_b32 s13, v1
    s_and_b32 s43, s2, 1
    s_lshl_b32 s43, s43, 3
    s_bfe_u32 s31, s2, 0x30003
    s_add_u32 s43, s43, s31
    s_lshr_b32 s31, s2, 6
    s_lshl_b32 s31, s31, 2
    s_bfe_u32 s32, s2, 0x20001
    s_add_u32 s31, s31, s32
    s_lshr_b32 s16, s31, 3
    s_and_b32 s33, s31, 7
    s_lshr_b32 s14, s13, 2
    s_and_b32 s30, s13, 3
    s_lshl_b32 s15, s43, 2
    s_add_u32 s15, s15, s30
    v_lshrrev_b32 v10, 3, v0
    v_and_b32 v11, 7, v0
    v_lshrrev_b32 v12, 1, v10
    v_xor_b32 v12, v12, v11
    v_lshlrev_b32 v5, 10, v10
    v_lshl_add_u32 v5, v12, 4, v5
    v_xor_b32 v6, 64, v5
    s_cmp_eq_u32 s16, 0
    s_mov_b32 s12, 3584
    s_cselect_b32 s12, 3072, s12
    s_cbranch_scc0 P1_zcols
    s_lshl_b32 s18, s33, 7
    s_add_u32 s19, s18, 1024
    s_add_u32 s20, s18, 2048
    s_mov_b32 s21, s20
    s_mov_b32 s34, 0
    s_branch P1_cdone
P1_zcols:
    s_lshr_b32 s21, s33, 1
    s_add_u32 s21, s21, 10
    s_lshl_b32 s21, s21, 7
    s_cmp_lt_u32 s33, 6
    s_cbranch_scc0 P1_z67
    s_lshl_b32 s18, s33, 8
    s_add_u32 s18, s18, 1792
    s_add_u32 s19, s18, 128
    s_lshl_b32 s20, s33, 7
    s_mov_b32 s34, 2
    s_branch P1_cdone
P1_z67:
    s_lshl_b32 s18, s33, 7
    s_add_u32 s18, s18, 2560
    s_lshl_b32 s19, s33, 8
    s_sub_u32 s19, s19, 768
    s_add_u32 s20, s19, 128
    s_mov_b32 s34, 1
P1_cdone:
    s_add_u32 s23, s13, s43
    s_and_b32 s23, s23, 7
    s_lshl_b32 s22, s23, 5
    s_mul_i32 s22, s22, s12
    s_lshl_b32 s23, s23, 12
    s_add_u32 s67, s31, s30
    s_lshl_b32 s38, s12, 3
    v_mul_u32_u24 v2, s12, v10
    v_and_b32 v10, 2, v10
    v_lshlrev_b32 v10, 1, v10
    v_xor_b32 v11, v11, v10
    v_lshl_add_u32 v2, v11, 4, v2
    s_lshl_b32 s24, s15, 15
    s_lshl_b32 s37, s30, 13
    s_lshl_b32 s27, s14, 16
    s_add_u32 s25, s27, s37
    s_lshl_b32 s32, s14, 1
    s_add_u32 s32, s32, s67
    s_waitcnt lgkmcnt(0)
    s_mov_b32 s48, s44
    s_mov_b32 s49, s45
    s_mov_b32 s50, 2097152
    s_mov_b32 s51, 0x20000
    s_cmp_eq_u32 s16, 0
    s_cselect_b32 s8, s46, s28
    s_cselect_b32 s9, s47, s29
    s_mov_b32 s10, 1835008
    s_cselect_b32 s10, 1572864, s10
    s_mov_b32 s11, 0x20000
    s_cmp_lt_u32 s13, 1
    s_cbranch_scc0 P1_t0
    v_mul_u32_u24 v7, s12, v0
    s_and_b32 s26, s43, 7
    s_mul_i32 s26, s26, s38
    s_lshl_b32 s26, s26, 3
    s_cmp_eq_u32 s13, 0
    s_cselect_b32 s27, s18, s19
    s_add_u32 s26, s26, s27
    buffer_load_dword v115, v7, s[8:11], s26 offen
P1_t0:
    s_add_u32 s31, s32, 0
    s_and_b32 s31, s31, 3
    s_lshl_b32 s31, s31, 8
    s_add_u32 s31, s31, s24
    s_add_u32 m0, s25, 32768
    s_add_u32 s3, s31, 0
    buffer_load_dwordx4 v5, s[48:51], s3 offen lds
    s_add_u32 m0, s25, 33792
    s_add_u32 s3, s31, 8192
    buffer_load_dwordx4 v6, s[48:51], s3 offen lds
    s_add_u32 m0, s25, 34816
    s_add_u32 s3, s31, 16384
    buffer_load_dwordx4 v5, s[48:51], s3 offen lds
    s_add_u32 m0, s25, 35840
    s_add_u32 s3, s31, 24576
    buffer_load_dwordx4 v6, s[48:51], s3 offen lds
    s_add_u32 m0, s25, 36864
    s_add_u32 s3, s31, 128
    buffer_load_dwordx4 v5, s[48:51], s3 offen lds
    s_add_u32 m0, s25, 37888
    s_add_u32 s3, s31, 8320
    buffer_load_dwordx4 v6, s[48:51], s3 offen lds
    s_add_u32 m0, s25, 38912
    s_add_u32 s3, s31, 16512
    buffer_load_dwordx4 v5, s[48:51], s3 offen lds
    s_add_u32 m0, s25, 39936
    s_add_u32 s3, s31, 24704
    buffer_load_dwordx4 v6, s[48:51], s3 offen lds
    s_cmp_eq_u32 s14, 0
    s_cbranch_scc0 P1_x1
    s_add_u32 s31, s32, 1
    s_and_b32 s31, s31, 3
    s_lshl_b32 s31, s31, 8
    s_add_u32 s31, s31, s24
    s_add_u32 m0, s25, 65536
    s_add_u32 s3, s31, 0
    buffer_load_dwordx4 v5, s[48:51], s3 offen lds
    s_add_u32 m0, s25, 66560
    s_add_u32 s3, s31, 8192
    buffer_load_dwordx4 v6, s[48:51], s3 offen lds
    s_add_u32 m0, s25, 67584
    s_add_u32 s3, s31, 16384
    buffer_load_dwordx4 v5, s[48:51], s3 offen lds
    s_add_u32 m0, s25, 68608
    s_add_u32 s3, s31, 24576
    buffer_load_dwordx4 v6, s[48:51], s3 offen lds
    s_add_u32 m0, s25, 69632
    s_add_u32 s3, s31, 128
    buffer_load_dwordx4 v5, s[48:51], s3 offen lds
    s_add_u32 m0, s25, 70656
    s_add_u32 s3, s31, 8320
    buffer_load_dwordx4 v6, s[48:51], s3 offen lds
    s_add_u32 m0, s25, 71680
    s_add_u32 s3, s31, 16512
    buffer_load_dwordx4 v5, s[48:51], s3 offen lds
    s_add_u32 m0, s25, 72704
    s_add_u32 s3, s31, 24704
    buffer_load_dwordx4 v6, s[48:51], s3 offen lds
P1_x1:
    s_and_b32 s26, s43, 7
    s_mul_i32 s26, s26, s38
    s_lshl_b32 s26, s26, 3
    s_cmp_eq_u32 s30, 2
    s_cselect_b32 s55, s20, s21
    s_add_u32 s55, s55, s26
    s_mov_b32 s54, s12
    s_mov_b64 s[72:73], s[8:9]
    s_mov_b32 s75, 0x20000
    s_cmp_lt_u32 s13, 6
    s_cselect_b32 s74, 0, s10
    v_mul_u32_u24 v122, s54, v0
    v_lshlrev_b32 v1, 4, v0
    s_add_u32 s26, s4, 29097984
    s_addc_u32 s27, s5, 0
    s_load_dword s41, s[26:27], 0
    v_and_b32 v12, 31, v0
    v_lshlrev_b32 v8, 7, v12
    v_bfe_u32 v13, v0, 1, 3
    v_lshrrev_b32 v14, 5, v0
    v_xor_b32 v13, v13, v14
    v_lshl_add_u32 v8, v13, 4, v8
    v_add_u32 v8, s37, v8
    v_add_u32 v8, 0x8000, v8
    v_xor_b32 v9, 32, v8
    v_xor_b32 v10, 64, v8
    v_xor_b32 v11, 96, v8
    v_bfe_u32 v13, v0, 4, 1
    v_and_b32 v15, 3, v0
    v_lshlrev_b32 v15, 3, v15
    v_lshl_add_u32 v15, v13, 5, v15
    v_lshlrev_b32 v123, 17, v13
    v_bfe_u32 v13, v0, 2, 2
    v_lshl_add_u32 v16, v14, 3, v13
    v_lshl_add_u32 v3, v16, 7, v15
    v_mul_u32_u24 v109, 72, v16
    v_add_u32 v109, v109, v15
    v_lshrrev_b32 v13, 1, v13
    v_lshl_add_u32 v3, v13, 6, v3
    s_lshl_b32 s26, s23, 1
    v_add_u32 v109, s26, v109
    v_mul_u32_u24 v108, 72, v12
    v_lshl_add_u32 v108, v14, 3, v108
    v_add_u32 v108, s26, v108
    v_lshlrev_b32 v110, 4, v12
    v_lshl_add_u32 v110, v14, 11, v110
    s_lshl_b32 s26, s30, 9
    s_add_u32 s26, s26, 153600
    v_lshl_add_u32 v111, v0, 3, s26
    v_lshl_add_u32 v123, v14, 9, v123
    v_and_b32 v13, 15, v0
    v_lshl_add_u32 v123, v13, 4, v123
    v_mov_b32 v7, 0x3f803f80
    v_mov_b64 v[116:117], 0
    v_mov_b64 v[124:125], 0
    v_mov_b64 v[126:127], 0
    v_mov_b64 v[96:97], 0
    v_mov_b64 v[98:99], 0
    s_mov_b32 exec_lo, 0x100001
    s_mov_b32 exec_hi, 0x100001
    v_mov_b32 v96, v7
    v_mov_b32 v97, v7
    v_mov_b32 v98, v7
    v_mov_b32 v99, v7
    s_mov_b64 exec, -1
    s_and_b32 s42, s33, 1
    s_mov_b32 s98, 100000000
    s_mul_i32 s39, s12, 232
    s_cmp_eq_u32 s16, 0
    s_cbranch_scc0 P1_zb
    s_lshl_b32 s26, s33, 2
    s_lshl_b32 s27, s14, 1
    s_add_u32 s26, s26, s27
    s_lshl_b32 s26, s26, 6
    s_add_u32 s26, s26, s15
    s_lshl_b32 s27, s26, 10
    s_add_u32 s27, s27, 2097152
    s_add_u32 s56, s4, s27
    s_addc_u32 s57, s5, 0
    s_lshl_b32 s27, s26, 11
    s_add_u32 s27, s27, 4194304
    s_add_u32 s58, s4, s27
    s_addc_u32 s59, s5, 0
    s_mov_b64 s[60:61], s[58:59]
    s_mov_b64 s[62:63], s[58:59]
    s_mov_b64 s[78:79], s[58:59]
    s_mov_b64 s[82:83], s[58:59]
    s_mov_b64 s[84:85], s[58:59]
    s_mov_b64 s[86:87], s[58:59]
    s_mov_b64 s[88:89], s[58:59]
    s_mov_b64 s[80:81], s[58:59]
    s_branch P1_bd
P1_zb:
    s_mul_i32 s27, s15, 28
    s_lshr_b32 s26, s19, 6
    s_add_u32 s26, s26, s14
    s_add_u32 s26, s26, s27
    s_lshl_b32 s26, s26, 11
    s_add_u32 s26, s26, 8454144
    s_add_u32 s58, s4, s26
    s_addc_u32 s59, s5, 0
    s_lshr_b32 s26, s20, 6
    s_add_u32 s26, s26, s14
    s_add_u32 s26, s26, s27
    s_lshl_b32 s26, s26, 11
    s_add_u32 s26, s26, 8454144
    s_add_u32 s60, s4, s26
    s_addc_u32 s61, s5, 0
    s_lshr_b32 s26, s21, 6
    s_add_u32 s26, s26, s42
    s_add_u32 s26, s26, s27
    s_lshl_b32 s26, s26, 11
    s_add_u32 s26, s26, 8454144
    s_add_u32 s62, s4, s26
    s_addc_u32 s63, s5, 0
    s_lshl_b32 s26, s43, 3
    s_add_u32 s26, s26, s33
    s_lshl_b32 s26, s26, 1
    s_add_u32 s26, s26, s14
    s_lshl_b32 s26, s26, 11
    s_lshl_b32 s27, s30, 9
    s_add_u32 s26, s26, s27
    s_add_u32 s26, s26, 28311552
    s_add_u32 s56, s4, s26
    s_addc_u32 s57, s5, 0
    s_lshl_b32 s26, s43, 15
    s_add_u32 s26, s26, s27
    s_add_u32 s26, s26, 28315648
    s_add_u32 s80, s4, s26
    s_addc_u32 s81, s5, 0
    s_add_u32 s82, s80, 8192
    s_addc_u32 s83, s81, 0
    s_add_u32 s84, s80, 16384
    s_addc_u32 s85, s81, 0
    s_add_u32 s86, s80, 24576
    s_addc_u32 s87, s81, 0
    s_sub_u32 s26, s18, 1792
    s_lshr_b32 s26, s26, 6
    s_add_u32 s26, s26, s14
    s_lshl_b32 s26, s26, 6
    s_add_u32 s26, s26, s15
    s_lshl_b32 s26, s26, 11
    s_add_u32 s26, s26, 16777216
    s_add_u32 s88, s4, s26
    s_addc_u32 s89, s5, 0
    s_add_u32 s78, s88, 262144
    s_addc_u32 s79, s89, 0
P1_bd:
    s_lshl_b32 s26, s16, 3
    s_add_u32 s26, s26, s33
    s_lshl_b32 s26, s26, 5
    s_add_u32 s26, s26, s43
    s_lshl_b32 s26, s26, 2
    s_add_u32 s66, s26, 29163520
    s_mov_b64 s[64:65], s[56:57]
    s_cmp_eq_u32 s14, 0
    s_cselect_b64 vcc, 0, -1
    s_cbranch_vccnz P1_nw0
    s_waitcnt vmcnt(8)
P1_nw0:
    s_barrier
    s_cbranch_vccnz P1_b0
    s_add_u32 s26, s18, s22
    s_add_u32 m0, s23, 0
    s_nop 0
    buffer_load_dwordx4 v2, s[8:11], s26 offen lds
    s_add_u32 m0, s23, 1024
    s_add_u32 s26, s26, s38
    buffer_load_dwordx4 v2, s[8:11], s26 offen lds
    s_add_u32 m0, s23, 2048
    s_add_u32 s26, s26, s38
    buffer_load_dwordx4 v2, s[8:11], s26 offen lds
    s_add_u32 m0, s23, 3072
    s_add_u32 s26, s26, s38
    buffer_load_dwordx4 v2, s[8:11], s26 offen lds
    s_branch P1_b0d
P1_b0:
    s_add_u32 s31, s32, 1
    s_and_b32 s31, s31, 3
    s_lshl_b32 s31, s31, 8
    s_add_u32 s31, s31, s24
    s_add_u32 m0, s25, 65536
    s_add_u32 s3, s31, 0
    buffer_load_dwordx4 v5, s[48:51], s3 offen lds
    s_add_u32 m0, s25, 66560
    s_add_u32 s3, s31, 8192
    buffer_load_dwordx4 v6, s[48:51], s3 offen lds
    s_add_u32 m0, s25, 67584
    s_add_u32 s3, s31, 16384
    buffer_load_dwordx4 v5, s[48:51], s3 offen lds
    s_add_u32 m0, s25, 68608
    s_add_u32 s3, s31, 24576
    buffer_load_dwordx4 v6, s[48:51], s3 offen lds
    s_add_u32 m0, s25, 69632
    s_add_u32 s3, s31, 128
    buffer_load_dwordx4 v5, s[48:51], s3 offen lds
    s_add_u32 m0, s25, 70656
    s_add_u32 s3, s31, 8320
    buffer_load_dwordx4 v6, s[48:51], s3 offen lds
    s_add_u32 m0, s25, 71680
    s_add_u32 s3, s31, 16512
    buffer_load_dwordx4 v5, s[48:51], s3 offen lds
    s_add_u32 m0, s25, 72704
    s_add_u32 s3, s31, 24704
    buffer_load_dwordx4 v6, s[48:51], s3 offen lds
P1_b0d:
    ds_read_b128 v[128:131], v8 offset:0
    ds_read_b128 v[132:135], v9 offset:0
    ds_read_b128 v[136:139], v10 offset:0
    ds_read_b128 v[140:143], v11 offset:0
    ds_read_b128 v[144:147], v8 offset:4096
    ds_read_b128 v[148:151], v9 offset:4096
    ds_read_b128 v[152:155], v10 offset:4096
    ds_read_b128 v[156:159], v11 offset:4096
    v_add_u32 v8, 0x8000, v8
    v_add_u32 v9, 0x8000, v9
    v_add_u32 v10, 0x8000, v10
    v_add_u32 v11, 0x8000, v11
    s_cbranch_vccz P1_xd0
    s_waitcnt lgkmcnt(4)
    v_dot2c_f32_bf16 v116, v128, v7
    v_dot2c_f32_bf16 v117, v128, v128
    v_dot2c_f32_bf16 v116, v129, v7
    v_dot2c_f32_bf16 v117, v129, v129
    v_dot2c_f32_bf16 v116, v130, v7
    v_dot2c_f32_bf16 v117, v130, v130
    v_dot2c_f32_bf16 v116, v131, v7
    v_dot2c_f32_bf16 v117, v131, v131
    v_dot2c_f32_bf16 v116, v132, v7
    v_dot2c_f32_bf16 v117, v132, v132
    v_dot2c_f32_bf16 v116, v133, v7
    v_dot2c_f32_bf16 v117, v133, v133
    v_dot2c_f32_bf16 v116, v134, v7
    v_dot2c_f32_bf16 v117, v134, v134
    v_dot2c_f32_bf16 v116, v135, v7
    v_dot2c_f32_bf16 v117, v135, v135
    v_dot2c_f32_bf16 v116, v136, v7
    v_dot2c_f32_bf16 v117, v136, v136
    v_dot2c_f32_bf16 v116, v137, v7
    v_dot2c_f32_bf16 v117, v137, v137
    v_dot2c_f32_bf16 v116, v138, v7
    v_dot2c_f32_bf16 v117, v138, v138
    v_dot2c_f32_bf16 v116, v139, v7
    v_dot2c_f32_bf16 v117, v139, v139
    v_dot2c_f32_bf16 v116, v140, v7
    v_dot2c_f32_bf16 v117, v140, v140
    v_dot2c_f32_bf16 v116, v141, v7
    v_dot2c_f32_bf16 v117, v141, v141
    v_dot2c_f32_bf16 v116, v142, v7
    v_dot2c_f32_bf16 v117, v142, v142
    v_dot2c_f32_bf16 v116, v143, v7
    v_dot2c_f32_bf16 v117, v143, v143
    s_waitcnt lgkmcnt(0)
    v_dot2c_f32_bf16 v116, v144, v7
    v_dot2c_f32_bf16 v117, v144, v144
    v_dot2c_f32_bf16 v116, v145, v7
    v_dot2c_f32_bf16 v117, v145, v145
    v_dot2c_f32_bf16 v116, v146, v7
    v_dot2c_f32_bf16 v117, v146, v146
    v_dot2c_f32_bf16 v116, v147, v7
    v_dot2c_f32_bf16 v117, v147, v147
    v_dot2c_f32_bf16 v116, v148, v7
    v_dot2c_f32_bf16 v117, v148, v148
    v_dot2c_f32_bf16 v116, v149, v7
    v_dot2c_f32_bf16 v117, v149, v149
    v_dot2c_f32_bf16 v116, v150, v7
    v_dot2c_f32_bf16 v117, v150, v150
    v_dot2c_f32_bf16 v116, v151, v7
    v_dot2c_f32_bf16 v117, v151, v151
    v_dot2c_f32_bf16 v116, v152, v7
    v_dot2c_f32_bf16 v117, v152, v152
    v_dot2c_f32_bf16 v116, v153, v7
    v_dot2c_f32_bf16 v117, v153, v153
    v_dot2c_f32_bf16 v116, v154, v7
    v_dot2c_f32_bf16 v117, v154, v154
    v_dot2c_f32_bf16 v116, v155, v7
    v_dot2c_f32_bf16 v117, v155, v155
    v_dot2c_f32_bf16 v116, v156, v7
    v_dot2c_f32_bf16 v117, v156, v156
    v_dot2c_f32_bf16 v116, v157, v7
    v_dot2c_f32_bf16 v117, v157, v157
    v_dot2c_f32_bf16 v116, v158, v7
    v_dot2c_f32_bf16 v117, v158, v158
    v_dot2c_f32_bf16 v116, v159, v7
    v_dot2c_f32_bf16 v117, v159, v159
P1_xd0:
    s_waitcnt lgkmcnt(0)
    s_cbranch_vccnz P1_nw1
    s_waitcnt vmcnt(4)
P1_nw1:
    s_barrier
    s_cbranch_vccz P1_b1
    s_add_u32 s26, s18, s22
    s_add_u32 m0, s23, 0
    s_nop 0
    buffer_load_dwordx4 v2, s[8:11], s26 offen lds
    s_add_u32 m0, s23, 1024
    s_add_u32 s26, s26, s38
    buffer_load_dwordx4 v2, s[8:11], s26 offen lds
    s_add_u32 m0, s23, 2048
    s_add_u32 s26, s26, s38
    buffer_load_dwordx4 v2, s[8:11], s26 offen lds
    s_add_u32 m0, s23, 3072
    s_add_u32 s26, s26, s38
    buffer_load_dwordx4 v2, s[8:11], s26 offen lds
P1_b1:
    s_add_u32 s26, s18, s22
    s_lshl_b32 s27, s12, 8
    s_add_u32 s26, s26, s27
    s_add_u32 m0, s23, 32768
    s_nop 0
    buffer_load_dwordx4 v2, s[8:11], s26 offen lds
    s_add_u32 m0, s23, 33792
    s_add_u32 s26, s26, s38
    buffer_load_dwordx4 v2, s[8:11], s26 offen lds
    s_add_u32 m0, s23, 34816
    s_add_u32 s26, s26, s38
    buffer_load_dwordx4 v2, s[8:11], s26 offen lds
    s_add_u32 m0, s23, 35840
    s_add_u32 s26, s26, s38
    buffer_load_dwordx4 v2, s[8:11], s26 offen lds
    ds_read_b128 v[160:163], v8 offset:0
    ds_read_b128 v[164:167], v9 offset:0
    ds_read_b128 v[168:171], v10 offset:0
    ds_read_b128 v[172:175], v11 offset:0
    ds_read_b128 v[176:179], v8 offset:4096
    ds_read_b128 v[180:183], v9 offset:4096
    ds_read_b128 v[184:187], v10 offset:4096
    ds_read_b128 v[188:191], v11 offset:4096
    v_add_u32 v8, 0x8000, v8
    v_add_u32 v9, 0x8000, v9
    v_add_u32 v10, 0x8000, v10
    v_add_u32 v11, 0x8000, v11
    s_cbranch_vccz P1_xd1
    s_waitcnt lgkmcnt(4)
    v_dot2c_f32_bf16 v116, v160, v7
    v_dot2c_f32_bf16 v117, v160, v160
    v_dot2c_f32_bf16 v116, v161, v7
    v_dot2c_f32_bf16 v117, v161, v161
    v_dot2c_f32_bf16 v116, v162, v7
    v_dot2c_f32_bf16 v117, v162, v162
    v_dot2c_f32_bf16 v116, v163, v7
    v_dot2c_f32_bf16 v117, v163, v163
    v_dot2c_f32_bf16 v116, v164, v7
    v_dot2c_f32_bf16 v117, v164, v164
    v_dot2c_f32_bf16 v116, v165, v7
    v_dot2c_f32_bf16 v117, v165, v165
    v_dot2c_f32_bf16 v116, v166, v7
    v_dot2c_f32_bf16 v117, v166, v166
    v_dot2c_f32_bf16 v116, v167, v7
    v_dot2c_f32_bf16 v117, v167, v167
    v_dot2c_f32_bf16 v116, v168, v7
    v_dot2c_f32_bf16 v117, v168, v168
    v_dot2c_f32_bf16 v116, v169, v7
    v_dot2c_f32_bf16 v117, v169, v169
    v_dot2c_f32_bf16 v116, v170, v7
    v_dot2c_f32_bf16 v117, v170, v170
    v_dot2c_f32_bf16 v116, v171, v7
    v_dot2c_f32_bf16 v117, v171, v171
    v_dot2c_f32_bf16 v116, v172, v7
    v_dot2c_f32_bf16 v117, v172, v172
    v_dot2c_f32_bf16 v116, v173, v7
    v_dot2c_f32_bf16 v117, v173, v173
    v_dot2c_f32_bf16 v116, v174, v7
    v_dot2c_f32_bf16 v117, v174, v174
    v_dot2c_f32_bf16 v116, v175, v7
    v_dot2c_f32_bf16 v117, v175, v175
    s_waitcnt lgkmcnt(0)
    v_dot2c_f32_bf16 v116, v176, v7
    v_dot2c_f32_bf16 v117, v176, v176
    v_dot2c_f32_bf16 v116, v177, v7
    v_dot2c_f32_bf16 v117, v177, v177
    v_dot2c_f32_bf16 v116, v178, v7
    v_dot2c_f32_bf16 v117, v178, v178
    v_dot2c_f32_bf16 v116, v179, v7
    v_dot2c_f32_bf16 v117, v179, v179
    v_dot2c_f32_bf16 v116, v180, v7
    v_dot2c_f32_bf16 v117, v180, v180
    v_dot2c_f32_bf16 v116, v181, v7
    v_dot2c_f32_bf16 v117, v181, v181
    v_dot2c_f32_bf16 v116, v182, v7
    v_dot2c_f32_bf16 v117, v182, v182
    v_dot2c_f32_bf16 v116, v183, v7
    v_dot2c_f32_bf16 v117, v183, v183
    v_dot2c_f32_bf16 v116, v184, v7
    v_dot2c_f32_bf16 v117, v184, v184
    v_dot2c_f32_bf16 v116, v185, v7
    v_dot2c_f32_bf16 v117, v185, v185
    v_dot2c_f32_bf16 v116, v186, v7
    v_dot2c_f32_bf16 v117, v186, v186
    v_dot2c_f32_bf16 v116, v187, v7
    v_dot2c_f32_bf16 v117, v187, v187
    v_dot2c_f32_bf16 v116, v188, v7
    v_dot2c_f32_bf16 v117, v188, v188
    v_dot2c_f32_bf16 v116, v189, v7
    v_dot2c_f32_bf16 v117, v189, v189
    v_dot2c_f32_bf16 v116, v190, v7
    v_dot2c_f32_bf16 v117, v190, v190
    v_dot2c_f32_bf16 v116, v191, v7
    v_dot2c_f32_bf16 v117, v191, v191
P1_xd1:
    s_waitcnt lgkmcnt(0)
    s_cbranch_vccz P1_nw2
    s_waitcnt vmcnt(16)
P1_nw2:
    s_barrier
    s_add_u32 s26, s19, s22
    s_add_u32 m0, s23, 65536
    s_nop 0
    buffer_load_dwordx4 v2, s[8:11], s26 offen lds
    s_add_u32 m0, s23, 66560
    s_add_u32 s26, s26, s38
    buffer_load_dwordx4 v2, s[8:11], s26 offen lds
    s_add_u32 m0, s23, 67584
    s_add_u32 s26, s26, s38
    buffer_load_dwordx4 v2, s[8:11], s26 offen lds
    s_add_u32 m0, s23, 68608
    s_add_u32 s26, s26, s38
    buffer_load_dwordx4 v2, s[8:11], s26 offen lds
    ds_read_b128 v[192:195], v8 offset:0
    ds_read_b128 v[196:199], v9 offset:0
    ds_read_b128 v[200:203], v10 offset:0
    ds_read_b128 v[204:207], v11 offset:0
    ds_read_b128 v[208:211], v8 offset:4096
    ds_read_b128 v[212:215], v9 offset:4096
    ds_read_b128 v[216:219], v10 offset:4096
    ds_read_b128 v[220:223], v11 offset:4096
    v_add_u32 v8, 0x8000, v8
    v_add_u32 v9, 0x8000, v9
    v_add_u32 v10, 0x8000, v10
    v_add_u32 v11, 0x8000, v11
    s_cbranch_vccz P1_xd2
    s_waitcnt lgkmcnt(4)
    v_dot2c_f32_bf16 v116, v192, v7
    v_dot2c_f32_bf16 v117, v192, v192
    v_dot2c_f32_bf16 v116, v193, v7
    v_dot2c_f32_bf16 v117, v193, v193
    v_dot2c_f32_bf16 v116, v194, v7
    v_dot2c_f32_bf16 v117, v194, v194
    v_dot2c_f32_bf16 v116, v195, v7
    v_dot2c_f32_bf16 v117, v195, v195
    v_dot2c_f32_bf16 v116, v196, v7
    v_dot2c_f32_bf16 v117, v196, v196
    v_dot2c_f32_bf16 v116, v197, v7
    v_dot2c_f32_bf16 v117, v197, v197
    v_dot2c_f32_bf16 v116, v198, v7
    v_dot2c_f32_bf16 v117, v198, v198
    v_dot2c_f32_bf16 v116, v199, v7
    v_dot2c_f32_bf16 v117, v199, v199
    v_dot2c_f32_bf16 v116, v200, v7
    v_dot2c_f32_bf16 v117, v200, v200
    v_dot2c_f32_bf16 v116, v201, v7
    v_dot2c_f32_bf16 v117, v201, v201
    v_dot2c_f32_bf16 v116, v202, v7
    v_dot2c_f32_bf16 v117, v202, v202
    v_dot2c_f32_bf16 v116, v203, v7
    v_dot2c_f32_bf16 v117, v203, v203
    v_dot2c_f32_bf16 v116, v204, v7
    v_dot2c_f32_bf16 v117, v204, v204
    v_dot2c_f32_bf16 v116, v205, v7
    v_dot2c_f32_bf16 v117, v205, v205
    v_dot2c_f32_bf16 v116, v206, v7
    v_dot2c_f32_bf16 v117, v206, v206
    v_dot2c_f32_bf16 v116, v207, v7
    v_dot2c_f32_bf16 v117, v207, v207
    s_waitcnt lgkmcnt(0)
    v_dot2c_f32_bf16 v116, v208, v7
    v_dot2c_f32_bf16 v117, v208, v208
    v_dot2c_f32_bf16 v116, v209, v7
    v_dot2c_f32_bf16 v117, v209, v209
    v_dot2c_f32_bf16 v116, v210, v7
    v_dot2c_f32_bf16 v117, v210, v210
    v_dot2c_f32_bf16 v116, v211, v7
    v_dot2c_f32_bf16 v117, v211, v211
    v_dot2c_f32_bf16 v116, v212, v7
    v_dot2c_f32_bf16 v117, v212, v212
    v_dot2c_f32_bf16 v116, v213, v7
    v_dot2c_f32_bf16 v117, v213, v213
    v_dot2c_f32_bf16 v116, v214, v7
    v_dot2c_f32_bf16 v117, v214, v214
    v_dot2c_f32_bf16 v116, v215, v7
    v_dot2c_f32_bf16 v117, v215, v215
    v_dot2c_f32_bf16 v116, v216, v7
    v_dot2c_f32_bf16 v117, v216, v216
    v_dot2c_f32_bf16 v116, v217, v7
    v_dot2c_f32_bf16 v117, v217, v217
    v_dot2c_f32_bf16 v116, v218, v7
    v_dot2c_f32_bf16 v117, v218, v218
    v_dot2c_f32_bf16 v116, v219, v7
    v_dot2c_f32_bf16 v117, v219, v219
    v_dot2c_f32_bf16 v116, v220, v7
    v_dot2c_f32_bf16 v117, v220, v220
    v_dot2c_f32_bf16 v116, v221, v7
    v_dot2c_f32_bf16 v117, v221, v221
    v_dot2c_f32_bf16 v116, v222, v7
    v_dot2c_f32_bf16 v117, v222, v222
    v_dot2c_f32_bf16 v116, v223, v7
    v_dot2c_f32_bf16 v117, v223, v223
P1_xd2:
    s_waitcnt lgkmcnt(0)
    s_cbranch_vccz P1_nw3
    s_waitcnt vmcnt(12)
P1_nw3:
    s_barrier
    s_add_u32 s26, s19, s22
    s_lshl_b32 s27, s12, 8
    s_add_u32 s26, s26, s27
    s_add_u32 m0, s23, 98304
    s_nop 0
    buffer_load_dwordx4 v2, s[8:11], s26 offen lds
    s_add_u32 m0, s23, 99328
    s_add_u32 s26, s26, s38
    buffer_load_dwordx4 v2, s[8:11], s26 offen lds
    s_add_u32 m0, s23, 100352
    s_add_u32 s26, s26, s38
    buffer_load_dwordx4 v2, s[8:11], s26 offen lds
    s_add_u32 m0, s23, 101376
    s_add_u32 s26, s26, s38
    buffer_load_dwordx4 v2, s[8:11], s26 offen lds
    ds_read_b128 v[224:227], v8 offset:0
    ds_read_b128 v[228:231], v9 offset:0
    ds_read_b128 v[232:235], v10 offset:0
    ds_read_b128 v[236:239], v11 offset:0
    ds_read_b128 v[240:243], v8 offset:4096
    ds_read_b128 v[244:247], v9 offset:4096
    ds_read_b128 v[248:251], v10 offset:4096
    ds_read_b128 v[252:255], v11 offset:4096
    buffer_load_dword v11, v122, s[72:75], s55 offen
    s_mov_b32 s74, 0
    s_lshl_b32 s26, s14, 10
    s_add_u32 s26, s26, 131072
    v_add_u32 v8, s26, v1
    s_lshl_b32 s26, s30, 7
    s_add_u32 s26, s26, 151552
    v_lshl_add_u32 v9, v14, 4, s26
    s_lshr_b32 s26, s30, 1
    s_lshl_b32 s26, s26, 9
    s_and_b32 s27, s30, 1
    s_lshl_b32 s27, s27, 3
    s_add_u32 s26, s26, s27
    s_lshl_b32 s27, s14, 10
    s_add_u32 s26, s26, s27
    s_add_u32 s26, s26, 131072
    v_add_u32 v10, s26, v1
    v_mov_b32 v5, 155648
    s_mov_b32 exec_lo, 0
    v_add_u32 v10, v5, v1
    s_mov_b32 exec_lo, -1
    s_lshl_b32 s26, s14, 6
    v_xor_b32 v5, s26, v3
    s_add_u32 s26, s67, 0
    s_and_b32 s26, s26, 3
    s_lshl_b32 s26, s26, 14
    v_add_u32 v4, s26, v5
    s_add_u32 s26, s67, 1
    s_and_b32 s26, s26, 3
    s_lshl_b32 s26, s26, 14
    v_add_u32 v112, s26, v5
    s_add_u32 s26, s67, 2
    s_and_b32 s26, s26, 3
    s_lshl_b32 s26, s26, 14
    v_add_u32 v113, s26, v5
    s_add_u32 s26, s67, 3
    s_and_b32 s26, s26, 3
    s_lshl_b32 s26, s26, 14
    v_add_u32 v114, s26, v5
    s_mov_b32 s17, 0
    s_mov_b32 s35, s23
    s_add_u32 s37, s20, s22
    s_cbranch_vccz P1_xd3
    s_waitcnt lgkmcnt(4)
    v_dot2c_f32_bf16 v116, v224, v7
    v_dot2c_f32_bf16 v117, v224, v224
    v_dot2c_f32_bf16 v116, v225, v7
    v_dot2c_f32_bf16 v117, v225, v225
    v_dot2c_f32_bf16 v116, v226, v7
    v_dot2c_f32_bf16 v117, v226, v226
    v_dot2c_f32_bf16 v116, v227, v7
    v_dot2c_f32_bf16 v117, v227, v227
    v_dot2c_f32_bf16 v116, v228, v7
    v_dot2c_f32_bf16 v117, v228, v228
    v_dot2c_f32_bf16 v116, v229, v7
    v_dot2c_f32_bf16 v117, v229, v229
    v_dot2c_f32_bf16 v116, v230, v7
    v_dot2c_f32_bf16 v117, v230, v230
    v_dot2c_f32_bf16 v116, v231, v7
    v_dot2c_f32_bf16 v117, v231, v231
    v_dot2c_f32_bf16 v116, v232, v7
    v_dot2c_f32_bf16 v117, v232, v232
    v_dot2c_f32_bf16 v116, v233, v7
    v_dot2c_f32_bf16 v117, v233, v233
    v_dot2c_f32_bf16 v116, v234, v7
    v_dot2c_f32_bf16 v117, v234, v234
    v_dot2c_f32_bf16 v116, v235, v7
    v_dot2c_f32_bf16 v117, v235, v235
    v_dot2c_f32_bf16 v116, v236, v7
    v_dot2c_f32_bf16 v117, v236, v236
    v_dot2c_f32_bf16 v116, v237, v7
    v_dot2c_f32_bf16 v117, v237, v237
    v_dot2c_f32_bf16 v116, v238, v7
    v_dot2c_f32_bf16 v117, v238, v238
    v_dot2c_f32_bf16 v116, v239, v7
    v_dot2c_f32_bf16 v117, v239, v239
    s_waitcnt lgkmcnt(0)
    v_dot2c_f32_bf16 v116, v240, v7
    v_dot2c_f32_bf16 v117, v240, v240
    v_dot2c_f32_bf16 v116, v241, v7
    v_dot2c_f32_bf16 v117, v241, v241
    v_dot2c_f32_bf16 v116, v242, v7
    v_dot2c_f32_bf16 v117, v242, v242
    v_dot2c_f32_bf16 v116, v243, v7
    v_dot2c_f32_bf16 v117, v243, v243
    v_dot2c_f32_bf16 v116, v244, v7
    v_dot2c_f32_bf16 v117, v244, v244
    v_dot2c_f32_bf16 v116, v245, v7
    v_dot2c_f32_bf16 v117, v245, v245
    v_dot2c_f32_bf16 v116, v246, v7
    v_dot2c_f32_bf16 v117, v246, v246
    v_dot2c_f32_bf16 v116, v247, v7
    v_dot2c_f32_bf16 v117, v247, v247
    v_dot2c_f32_bf16 v116, v248, v7
    v_dot2c_f32_bf16 v117, v248, v248
    v_dot2c_f32_bf16 v116, v249, v7
    v_dot2c_f32_bf16 v117, v249, v249
    v_dot2c_f32_bf16 v116, v250, v7
    v_dot2c_f32_bf16 v117, v250, v250
    v_dot2c_f32_bf16 v116, v251, v7
    v_dot2c_f32_bf16 v117, v251, v251
    v_dot2c_f32_bf16 v116, v252, v7
    v_dot2c_f32_bf16 v117, v252, v252
    v_dot2c_f32_bf16 v116, v253, v7
    v_dot2c_f32_bf16 v117, v253, v253
    v_dot2c_f32_bf16 v116, v254, v7
    v_dot2c_f32_bf16 v117, v254, v254
    v_dot2c_f32_bf16 v116, v255, v7
    v_dot2c_f32_bf16 v117, v255, v255
P1_xd3:
    s_waitcnt vmcnt(9) lgkmcnt(0)
    s_xor_b32 s41, s41, 0x5bd1e995
    s_barrier
    s_cbranch_vccz P1_blkN
    v_mov_b32 v118, v116
    v_mov_b32 v119, v117
    s_nop 1
    v_permlane32_swap_b32 v116, v118
    v_permlane32_swap_b32 v117, v119
    v_add_f32 v116, v116, v118
    v_add_f32 v117, v117, v119
    v_mul_f32 v121, 0xbb000000, v116
    v_mul_f32 v117, 0x3b000000, v117
    v_fma_f32 v117, -v121, v121, v117
    v_max_f32 v117, 0, v117
    v_add_f32 v118, 0x3727c5ac, v117
    v_rsq_f32 v117, v118
    v_sqrt_f32 v118, v118
    v_cvt_pk_bf16_f32 v12, v121, v121
    v_and_b32 v120, 0xffff0000, v12
    v_sub_f32 v121, v121, v120
    v_cvt_pk_bf16_f32 v13, v121, 0
    v_mov_b32 v14, v12
    v_mul_f32 v116, 0x3eb8aa3b, v117
    v_mul_f32 v120, 0xc0135761, v117
    v_mul_f32 v119, v117, v117
    v_mov_b32 v15, v13
    v_mul_f32 v119, 0x3d372713, v119
    s_mul_i32 s26, s30, 3072
    s_add_u32 s26, s26, 139264
    v_add_u32 v5, s26, v1
    v_mul_f32 v119, v119, v120
    ds_write_b128 v5, v[12:15]
    ds_write_b128 v5, v[116:119] offset:1024
    ds_write_b32 v5, v120 offset:2048
    v_and_b32 v121, 31, v0
    v_lshlrev_b32 v121, 2, v121
    s_lshl_b32 s26, s30, 7
    s_add_u32 s26, s26, 151552
    v_add_u32 v121, s26, v121
    ds_write_b32 v121, v117
    v_mov_b32 v121, 152576
    s_waitcnt lgkmcnt(0)
    s_barrier
    s_branch P1_blkN
P1_blkD:
    ds_read_b64_tr_b16 v[32:33], v4 offset:0
    ds_read_b64_tr_b16 v[34:35], v4 offset:512
    ds_read_b64_tr_b16 v[36:37], v4 offset:2048
    ds_read_b64_tr_b16 v[38:39], v4 offset:2560
    ds_read_b64_tr_b16 v[40:41], v4 offset:4096
    ds_read_b64_tr_b16 v[42:43], v4 offset:4608
P1_blkD2:
    ds_read_b64_tr_b16 v[44:45], v4 offset:6144
    ds_read_b64_tr_b16 v[46:47], v4 offset:6656
    s_waitcnt lgkmcnt(6)
    v_mfma_f32_32x32x16_bf16 v[16:31], v[32:35], v[128:131], 0
    s_add_u32 m0, s35, 0
    s_nop 0
    buffer_load_dwordx4 v2, s[8:11], s37 offen lds
    ds_read_b64_tr_b16 v[32:33], v4 offset:8192
    ds_read_b64_tr_b16 v[34:35], v4 offset:8704
    s_waitcnt lgkmcnt(6)
    v_mfma_f32_32x32x16_bf16 v[16:31], v[36:39], v[132:135], v[16:31]
    ds_read_b64_tr_b16 v[36:37], v4 offset:10240
    ds_read_b64_tr_b16 v[38:39], v4 offset:10752
    s_waitcnt lgkmcnt(6)
    v_mfma_f32_32x32x16_bf16 v[16:31], v[40:43], v[136:139], v[16:31]
    s_add_u32 m0, s35, 1024
    s_add_u32 s37, s37, s38
    buffer_load_dwordx4 v2, s[8:11], s37 offen lds
    ds_read_b64_tr_b16 v[40:41], v4 offset:12288
    ds_read_b64_tr_b16 v[42:43], v4 offset:12800
    s_waitcnt lgkmcnt(6)
    v_mfma_f32_32x32x16_bf16 v[16:31], v[44:47], v[140:143], v[16:31]
    ds_read_b64_tr_b16 v[44:45], v4 offset:14336
    ds_read_b64_tr_b16 v[46:47], v4 offset:14848
    s_waitcnt lgkmcnt(6)
    v_mfma_f32_32x32x16_bf16 v[16:31], v[32:35], v[144:147], v[16:31]
    s_add_u32 m0, s35, 2048
    s_add_u32 s37, s37, s38
    buffer_load_dwordx4 v2, s[8:11], s37 offen lds
    ds_read_b64_tr_b16 v[32:33], v112 offset:0
    ds_read_b64_tr_b16 v[34:35], v112 offset:512
    s_waitcnt lgkmcnt(6)
    v_mfma_f32_32x32x16_bf16 v[16:31], v[36:39], v[148:151], v[16:31]
    ds_read_b64_tr_b16 v[36:37], v112 offset:2048
    ds_read_b64_tr_b16 v[38:39], v112 offset:2560
    s_waitcnt lgkmcnt(6)
    v_mfma_f32_32x32x16_bf16 v[16:31], v[40:43], v[152:155], v[16:31]
    s_add_u32 m0, s35, 3072
    s_add_u32 s37, s37, s38
    buffer_load_dwordx4 v2, s[8:11], s37 offen lds
    ds_read_b64_tr_b16 v[40:41], v112 offset:4096
    ds_read_b64_tr_b16 v[42:43], v112 offset:4608
    s_waitcnt lgkmcnt(6)
    v_mfma_f32_32x32x16_bf16 v[16:31], v[44:47], v[156:159], v[16:31]
    ds_read_b64_tr_b16 v[44:45], v112 offset:6144
    ds_read_b64_tr_b16 v[46:47], v112 offset:6656
    s_waitcnt lgkmcnt(6)
    v_mfma_f32_32x32x16_bf16 v[16:31], v[32:35], v[160:163], v[16:31]
    s_add_u32 m0, s35, 32768
    s_add_u32 s37, s37, s39
    buffer_load_dwordx4 v2, s[8:11], s37 offen lds
    ds_read_b64_tr_b16 v[32:33], v112 offset:8192
    ds_read_b64_tr_b16 v[34:35], v112 offset:8704
    s_waitcnt lgkmcnt(6)
    v_mfma_f32_32x32x16_bf16 v[16:31], v[36:39], v[164:167], v[16:31]
    ds_read_b64_tr_b16 v[36:37], v112 offset:10240
    ds_read_b64_tr_b16 v[38:39], v112 offset:10752
    s_waitcnt lgkmcnt(6)
    v_mfma_f32_32x32x16_bf16 v[16:31], v[40:43], v[168:171], v[16:31]
    s_add_u32 m0, s35, 33792
    s_add_u32 s37, s37, s38
    buffer_load_dwordx4 v2, s[8:11], s37 offen lds
    ds_read_b64_tr_b16 v[40:41], v112 offset:12288
    ds_read_b64_tr_b16 v[42:43], v112 offset:12800
    s_waitcnt lgkmcnt(6)
    v_mfma_f32_32x32x16_bf16 v[16:31], v[44:47], v[172:175], v[16:31]
    ds_read_b64_tr_b16 v[44:45], v112 offset:14336
    ds_read_b64_tr_b16 v[46:47], v112 offset:14848
    s_waitcnt lgkmcnt(6)
    v_mfma_f32_32x32x16_bf16 v[16:31], v[32:35], v[176:179], v[16:31]
    s_add_u32 m0, s35, 34816
    s_add_u32 s37, s37, s38
    buffer_load_dwordx4 v2, s[8:11], s37 offen lds
    ds_read_b64_tr_b16 v[48:49], v113 offset:0
    ds_read_b64_tr_b16 v[50:51], v113 offset:512
    s_waitcnt lgkmcnt(6)
    v_mfma_f32_32x32x16_bf16 v[16:31], v[36:39], v[180:183], v[16:31]
    ds_read_b64_tr_b16 v[52:53], v113 offset:2048
    ds_read_b64_tr_b16 v[54:55], v113 offset:2560
    s_waitcnt lgkmcnt(6)
    v_mfma_f32_32x32x16_bf16 v[16:31], v[40:43], v[184:187], v[16:31]
    s_add_u32 m0, s35, 35840
    s_add_u32 s37, s37, s38
    buffer_load_dwordx4 v2, s[8:11], s37 offen lds
    ds_read_b64_tr_b16 v[56:57], v113 offset:4096
    ds_read_b64_tr_b16 v[58:59], v113 offset:4608
    s_waitcnt lgkmcnt(6)
    v_mfma_f32_32x32x16_bf16 v[16:31], v[44:47], v[188:191], v[16:31]
    s_add_u32 s37, s21, s22
    s_xor_b32 s35, s35, 0x10000
    ds_read_b64_tr_b16 v[60:61], v113 offset:6144
    ds_read_b64_tr_b16 v[62:63], v113 offset:6656
    s_waitcnt lgkmcnt(6)
    v_mfma_f32_32x32x16_bf16 v[16:31], v[48:51], v[192:195], v[16:31]
    buffer_load_dword v11, v122, s[72:75], s55 offen
    ds_read_b64_tr_b16 v[64:65], v113 offset:8192
    ds_read_b64_tr_b16 v[66:67], v113 offset:8704
    s_waitcnt lgkmcnt(6)
    v_mfma_f32_32x32x16_bf16 v[16:31], v[52:55], v[196:199], v[16:31]
    ds_read_b64_tr_b16 v[68:69], v113 offset:10240
    ds_read_b64_tr_b16 v[70:71], v113 offset:10752
    s_waitcnt lgkmcnt(6)
    v_mfma_f32_32x32x16_bf16 v[16:31], v[56:59], v[200:203], v[16:31]
    ds_read_b64_tr_b16 v[72:73], v113 offset:12288
    ds_read_b64_tr_b16 v[74:75], v113 offset:12800
    s_waitcnt lgkmcnt(6)
    v_mfma_f32_32x32x16_bf16 v[16:31], v[60:63], v[204:207], v[16:31]
    ds_read_b64_tr_b16 v[76:77], v113 offset:14336
    ds_read_b64_tr_b16 v[78:79], v113 offset:14848
    s_waitcnt lgkmcnt(6)
    v_mfma_f32_32x32x16_bf16 v[16:31], v[64:67], v[208:211], v[16:31]
    ds_read_b64_tr_b16 v[32:33], v114 offset:0
    ds_read_b64_tr_b16 v[34:35], v114 offset:512
    s_waitcnt lgkmcnt(6)
    v_mfma_f32_32x32x16_bf16 v[16:31], v[68:71], v[212:215], v[16:31]
    ds_read_b64_tr_b16 v[36:37], v114 offset:2048
    ds_read_b64_tr_b16 v[38:39], v114 offset:2560
    s_waitcnt lgkmcnt(6)
    v_mfma_f32_32x32x16_bf16 v[16:31], v[72:75], v[216:219], v[16:31]
    ds_read_b64_tr_b16 v[40:41], v114 offset:4096
    ds_read_b64_tr_b16 v[42:43], v114 offset:4608
    s_waitcnt lgkmcnt(6)
    v_mfma_f32_32x32x16_bf16 v[16:31], v[76:79], v[220:223], v[16:31]
    v_mfma_f32_16x16x32_bf16 v[100:103], v[96:99], v[48:51], 0
    v_mfma_f32_16x16x32_bf16 v[100:103], v[96:99], v[52:55], v[100:103]
    v_mfma_f32_16x16x32_bf16 v[100:103], v[96:99], v[56:59], v[100:103]
    v_mfma_f32_16x16x32_bf16 v[100:103], v[96:99], v[60:63], v[100:103]
    v_mfma_f32_16x16x32_bf16 v[100:103], v[96:99], v[64:67], v[100:103]
    v_mfma_f32_16x16x32_bf16 v[100:103], v[96:99], v[68:71], v[100:103]
    v_mfma_f32_16x16x32_bf16 v[100:103], v[96:99], v[72:75], v[100:103]
    v_mfma_f32_16x16x32_bf16 v[100:103], v[96:99], v[76:79], v[100:103]
    ds_read_b64_tr_b16 v[44:45], v114 offset:6144
    ds_read_b64_tr_b16 v[46:47], v114 offset:6656
    ds_read_b64_tr_b16 v[48:49], v114 offset:8192
    ds_read_b64_tr_b16 v[50:51], v114 offset:8704
    ds_read_b64_tr_b16 v[52:53], v114 offset:10240
    ds_read_b64_tr_b16 v[54:55], v114 offset:10752
    s_waitcnt lgkmcnt(10)
    v_mfma_f32_32x32x16_bf16 v[16:31], v[32:35], v[224:227], v[16:31]
    ds_read_b64_tr_b16 v[56:57], v114 offset:12288
    ds_read_b64_tr_b16 v[58:59], v114 offset:12800
    ds_read_b64_tr_b16 v[60:61], v114 offset:14336
    ds_read_b64_tr_b16 v[62:63], v114 offset:14848
    s_waitcnt lgkmcnt(12)
    v_mfma_f32_32x32x16_bf16 v[16:31], v[36:39], v[228:231], v[16:31]
    v_cvt_pk_bf16_f32 v101, v100, v100
    v_and_b32 v101, 0xffff0000, v101
    v_sub_f32 v100, v100, v101
    v_cvt_pk_bf16_f32 v102, v101, v100
    v_lshrrev_b32 v103, 16, v101
    ds_write_b64 v10, v[102:103]
    s_waitcnt lgkmcnt(11)
    v_mfma_f32_32x32x16_bf16 v[16:31], v[40:43], v[232:235], v[16:31]
    v_add_u32 v10, 0x800, v10
    v_xor_b32 v4, 0x10000, v4
    v_xor_b32 v112, 0x10000, v112
    v_xor_b32 v113, 0x10000, v113
    v_xor_b32 v114, 0x10000, v114
    s_waitcnt lgkmcnt(9)
    v_mfma_f32_32x32x16_bf16 v[16:31], v[44:47], v[236:239], v[16:31]
    s_branch P1_md
P1_blkN:
    ds_read_b64_tr_b16 v[32:33], v4 offset:0
    ds_read_b64_tr_b16 v[34:35], v4 offset:512
    ds_read_b64_tr_b16 v[36:37], v4 offset:2048
    ds_read_b64_tr_b16 v[38:39], v4 offset:2560
    ds_read_b64_tr_b16 v[40:41], v4 offset:4096
    ds_read_b64_tr_b16 v[42:43], v4 offset:4608
    ds_read_b64_tr_b16 v[44:45], v4 offset:6144
    ds_read_b64_tr_b16 v[46:47], v4 offset:6656
    s_waitcnt lgkmcnt(6)
    v_mfma_f32_32x32x16_bf16 v[16:31], v[32:35], v[128:131], 0
    ds_read_b64_tr_b16 v[32:33], v4 offset:8192
    ds_read_b64_tr_b16 v[34:35], v4 offset:8704
    s_waitcnt lgkmcnt(6)
    v_mfma_f32_32x32x16_bf16 v[16:31], v[36:39], v[132:135], v[16:31]
    ds_read_b64_tr_b16 v[36:37], v4 offset:10240
    ds_read_b64_tr_b16 v[38:39], v4 offset:10752
    s_waitcnt lgkmcnt(6)
    v_mfma_f32_32x32x16_bf16 v[16:31], v[40:43], v[136:139], v[16:31]
    ds_read_b64_tr_b16 v[40:41], v4 offset:12288
    ds_read_b64_tr_b16 v[42:43], v4 offset:12800
    s_waitcnt lgkmcnt(6)
    v_mfma_f32_32x32x16_bf16 v[16:31], v[44:47], v[140:143], v[16:31]
    ds_read_b64_tr_b16 v[44:45], v4 offset:14336
    ds_read_b64_tr_b16 v[46:47], v4 offset:14848
    s_waitcnt lgkmcnt(6)
    v_mfma_f32_32x32x16_bf16 v[16:31], v[32:35], v[144:147], v[16:31]
    ds_read_b64_tr_b16 v[32:33], v112 offset:0
    ds_read_b64_tr_b16 v[34:35], v112 offset:512
    s_waitcnt lgkmcnt(6)
    v_mfma_f32_32x32x16_bf16 v[16:31], v[36:39], v[148:151], v[16:31]
    ds_read_b64_tr_b16 v[36:37], v112 offset:2048
    ds_read_b64_tr_b16 v[38:39], v112 offset:2560
    s_waitcnt lgkmcnt(6)
    v_mfma_f32_32x32x16_bf16 v[16:31], v[40:43], v[152:155], v[16:31]
    ds_read_b64_tr_b16 v[40:41], v112 offset:4096
    ds_read_b64_tr_b16 v[42:43], v112 offset:4608
    s_waitcnt lgkmcnt(6)
    v_mfma_f32_32x32x16_bf16 v[16:31], v[44:47], v[156:159], v[16:31]
    ds_read_b64_tr_b16 v[44:45], v112 offset:6144
    ds_read_b64_tr_b16 v[46:47], v112 offset:6656
    s_waitcnt lgkmcnt(6)
    v_mfma_f32_32x32x16_bf16 v[16:31], v[32:35], v[160:163], v[16:31]
    ds_read_b64_tr_b16 v[32:33], v112 offset:8192
    ds_read_b64_tr_b16 v[34:35], v112 offset:8704
    s_waitcnt lgkmcnt(6)
    v_mfma_f32_32x32x16_bf16 v[16:31], v[36:39], v[164:167], v[16:31]
    ds_read_b64_tr_b16 v[36:37], v112 offset:10240
    ds_read_b64_tr_b16 v[38:39], v112 offset:10752
    s_waitcnt lgkmcnt(6)
    v_mfma_f32_32x32x16_bf16 v[16:31], v[40:43], v[168:171], v[16:31]
    ds_read_b64_tr_b16 v[40:41], v112 offset:12288
    ds_read_b64_tr_b16 v[42:43], v112 offset:12800
    s_waitcnt lgkmcnt(6)
    v_mfma_f32_32x32x16_bf16 v[16:31], v[44:47], v[172:175], v[16:31]
    ds_read_b64_tr_b16 v[44:45], v112 offset:14336
    ds_read_b64_tr_b16 v[46:47], v112 offset:14848
    s_waitcnt lgkmcnt(6)
    v_mfma_f32_32x32x16_bf16 v[16:31], v[32:35], v[176:179], v[16:31]
    ds_read_b64_tr_b16 v[48:49], v113 offset:0
    ds_read_b64_tr_b16 v[50:51], v113 offset:512
    s_waitcnt lgkmcnt(6)
    v_mfma_f32_32x32x16_bf16 v[16:31], v[36:39], v[180:183], v[16:31]
    ds_read_b64_tr_b16 v[52:53], v113 offset:2048
    ds_read_b64_tr_b16 v[54:55], v113 offset:2560
    s_waitcnt lgkmcnt(6)
    v_mfma_f32_32x32x16_bf16 v[16:31], v[40:43], v[184:187], v[16:31]
    ds_read_b64_tr_b16 v[56:57], v113 offset:4096
    ds_read_b64_tr_b16 v[58:59], v113 offset:4608
    s_waitcnt lgkmcnt(6)
    v_mfma_f32_32x32x16_bf16 v[16:31], v[44:47], v[188:191], v[16:31]
    ds_read_b64_tr_b16 v[60:61], v113 offset:6144
    ds_read_b64_tr_b16 v[62:63], v113 offset:6656
    s_waitcnt lgkmcnt(6)
    v_mfma_f32_32x32x16_bf16 v[16:31], v[48:51], v[192:195], v[16:31]
    ds_read_b64_tr_b16 v[64:65], v113 offset:8192
    ds_read_b64_tr_b16 v[66:67], v113 offset:8704
    s_waitcnt lgkmcnt(6)
    v_mfma_f32_32x32x16_bf16 v[16:31], v[52:55], v[196:199], v[16:31]
    ds_read_b64_tr_b16 v[68:69], v113 offset:10240
    ds_read_b64_tr_b16 v[70:71], v113 offset:10752
    s_waitcnt lgkmcnt(6)
    v_mfma_f32_32x32x16_bf16 v[16:31], v[56:59], v[200:203], v[16:31]
    ds_read_b64_tr_b16 v[72:73], v113 offset:12288
    ds_read_b64_tr_b16 v[74:75], v113 offset:12800
    s_waitcnt lgkmcnt(6)
    v_mfma_f32_32x32x16_bf16 v[16:31], v[60:63], v[204:207], v[16:31]
    ds_read_b64_tr_b16 v[76:77], v113 offset:14336
    ds_read_b64_tr_b16 v[78:79], v113 offset:14848
    s_waitcnt lgkmcnt(6)
    v_mfma_f32_32x32x16_bf16 v[16:31], v[64:67], v[208:211], v[16:31]
    ds_read_b64_tr_b16 v[32:33], v114 offset:0
    ds_read_b64_tr_b16 v[34:35], v114 offset:512
    s_waitcnt lgkmcnt(6)
    v_mfma_f32_32x32x16_bf16 v[16:31], v[68:71], v[212:215], v[16:31]
    ds_read_b64_tr_b16 v[36:37], v114 offset:2048
    ds_read_b64_tr_b16 v[38:39], v114 offset:2560
    s_waitcnt lgkmcnt(6)
    v_mfma_f32_32x32x16_bf16 v[16:31], v[72:75], v[216:219], v[16:31]
    ds_read_b64_tr_b16 v[40:41], v114 offset:4096
    ds_read_b64_tr_b16 v[42:43], v114 offset:4608
    s_waitcnt lgkmcnt(6)
    v_mfma_f32_32x32x16_bf16 v[16:31], v[76:79], v[220:223], v[16:31]
    v_mfma_f32_16x16x32_bf16 v[100:103], v[96:99], v[48:51], 0
    v_mfma_f32_16x16x32_bf16 v[100:103], v[96:99], v[52:55], v[100:103]
    v_mfma_f32_16x16x32_bf16 v[100:103], v[96:99], v[56:59], v[100:103]
    v_mfma_f32_16x16x32_bf16 v[100:103], v[96:99], v[60:63], v[100:103]
    v_mfma_f32_16x16x32_bf16 v[100:103], v[96:99], v[64:67], v[100:103]
    v_mfma_f32_16x16x32_bf16 v[100:103], v[96:99], v[68:71], v[100:103]
    v_mfma_f32_16x16x32_bf16 v[100:103], v[96:99], v[72:75], v[100:103]
    v_mfma_f32_16x16x32_bf16 v[100:103], v[96:99], v[76:79], v[100:103]
    ds_read_b64_tr_b16 v[44:45], v114 offset:6144
    ds_read_b64_tr_b16 v[46:47], v114 offset:6656
    ds_read_b64_tr_b16 v[48:49], v114 offset:8192
    ds_read_b64_tr_b16 v[50:51], v114 offset:8704
    ds_read_b64_tr_b16 v[52:53], v114 offset:10240
    ds_read_b64_tr_b16 v[54:55], v114 offset:10752
    s_waitcnt lgkmcnt(10)
    v_mfma_f32_32x32x16_bf16 v[16:31], v[32:35], v[224:227], v[16:31]
    ds_read_b64_tr_b16 v[56:57], v114 offset:12288
    ds_read_b64_tr_b16 v[58:59], v114 offset:12800
    ds_read_b64_tr_b16 v[60:61], v114 offset:14336
    ds_read_b64_tr_b16 v[62:63], v114 offset:14848
    s_waitcnt lgkmcnt(12)
    v_mfma_f32_32x32x16_bf16 v[16:31], v[36:39], v[228:231], v[16:31]
    v_cvt_pk_bf16_f32 v101, v100, v100
    v_and_b32 v101, 0xffff0000, v101
    v_sub_f32 v100, v100, v101
    v_cvt_pk_bf16_f32 v102, v101, v100
    v_lshrrev_b32 v103, 16, v101
    ds_write_b64 v10, v[102:103]
    s_waitcnt lgkmcnt(11)
    v_mfma_f32_32x32x16_bf16 v[16:31], v[40:43], v[232:235], v[16:31]
    v_add_u32 v10, 0x800, v10
    v_xor_b32 v4, 0x10000, v4
    v_xor_b32 v112, 0x10000, v112
    v_xor_b32 v113, 0x10000, v113
    v_xor_b32 v114, 0x10000, v114
    s_waitcnt lgkmcnt(9)
    v_mfma_f32_32x32x16_bf16 v[16:31], v[44:47], v[236:239], v[16:31]
P1_md:
    s_or_b32 s26, s17, s14
    s_cbranch_vccz P1_s1
    s_waitcnt vmcnt(1)
P1_s1:
    s_setprio 2
    s_cmp_eq_u32 s26, 0
    s_waitcnt lgkmcnt(0)
    s_barrier
    ds_read_b128 v[104:107], v8
    v_mfma_f32_32x32x16_bf16 v[16:31], v[48:51], v[240:243], v[16:31]
    v_mfma_f32_32x32x16_bf16 v[16:31], v[52:55], v[244:247], v[16:31]
    v_mfma_f32_32x32x16_bf16 v[16:31], v[56:59], v[248:251], v[16:31]
    v_mfma_f32_32x32x16_bf16 v[16:31], v[60:63], v[252:255], v[16:31]
    s_cbranch_scc1 P1_getk
P1_havek:
    s_add_u32 s26, s17, s14
    s_cmp_eq_u32 s26, 3
    s_waitcnt lgkmcnt(0)
    v_mfma_f32_32x32x16_bf16 v[16:31], v[104:107], v[12:15], v[16:31]
    s_setprio 0
    s_cbranch_scc1 P1_gstart
    s_nop 6
P1_gret:
    v_add_u32 v8, 0x800, v8
P1_epi:
    s_cmp_eq_u32 s16, 0
    s_cbranch_scc1 P1_epiQK
    v_mul_f32 v48, v16, v16
    v_mul_f32 v49, v17, v17
    v_mul_f32 v50, v18, v18
    v_mul_f32 v51, v19, v19
    v_mul_f32 v52, v20, v20
    v_mul_f32 v53, v21, v21
    v_mul_f32 v54, v22, v22
    v_mul_f32 v55, v23, v23
    v_mul_f32 v56, v24, v24
    v_mul_f32 v57, v25, v25
    v_mul_f32 v58, v26, v26
    v_mul_f32 v59, v27, v27
    v_mul_f32 v60, v28, v28
    v_mul_f32 v61, v29, v29
    v_mul_f32 v62, v30, v30
    v_mul_f32 v63, v31, v31
    v_fma_f32 v48, v48, v119, v120
    v_fma_f32 v49, v49, v119, v120
    v_fma_f32 v50, v50, v119, v120
    v_fma_f32 v51, v51, v119, v120
    v_fma_f32 v52, v52, v119, v120
    v_fma_f32 v53, v53, v119, v120
    v_fma_f32 v54, v54, v119, v120
    v_fma_f32 v55, v55, v119, v120
    v_fma_f32 v56, v56, v119, v120
    v_fma_f32 v57, v57, v119, v120
    v_fma_f32 v58, v58, v119, v120
    v_fma_f32 v59, v59, v119, v120
    v_fma_f32 v60, v60, v119, v120
    v_fma_f32 v61, v61, v119, v120
    v_fma_f32 v62, v62, v119, v120
    v_fma_f32 v63, v63, v119, v120
    v_mul_f32 v48, v48, v16
    v_mul_f32 v49, v49, v17
    v_mul_f32 v50, v50, v18
    v_mul_f32 v51, v51, v19
    v_mul_f32 v52, v52, v20
    v_mul_f32 v53, v53, v21
    v_mul_f32 v54, v54, v22
    v_mul_f32 v55, v55, v23
    v_mul_f32 v56, v56, v24
    v_mul_f32 v57, v57, v25
    v_mul_f32 v58, v58, v26
    v_mul_f32 v59, v59, v27
    v_mul_f32 v60, v60, v28
    v_mul_f32 v61, v61, v29
    v_mul_f32 v62, v62, v30
    v_mul_f32 v63, v63, v31
    v_exp_f32 v48, v48
    v_exp_f32 v49, v49
    v_exp_f32 v50, v50
    v_exp_f32 v51, v51
    v_exp_f32 v52, v52
    v_exp_f32 v53, v53
    v_exp_f32 v54, v54
    v_exp_f32 v55, v55
    v_exp_f32 v56, v56
    v_exp_f32 v57, v57
    v_exp_f32 v58, v58
    v_exp_f32 v59, v59
    v_exp_f32 v60, v60
    v_exp_f32 v61, v61
    v_exp_f32 v62, v62
    v_exp_f32 v63, v63
    v_fma_f32 v48, v48, v118, v118
    v_fma_f32 v49, v49, v118, v118
    v_fma_f32 v50, v50, v118, v118
    v_fma_f32 v51, v51, v118, v118
    v_fma_f32 v52, v52, v118, v118
    v_fma_f32 v53, v53, v118, v118
    v_fma_f32 v54, v54, v118, v118
    v_fma_f32 v55, v55, v118, v118
    v_fma_f32 v56, v56, v118, v118
    v_fma_f32 v57, v57, v118, v118
    v_fma_f32 v58, v58, v118, v118
    v_fma_f32 v59, v59, v118, v118
    v_fma_f32 v60, v60, v118, v118
    v_fma_f32 v61, v61, v118, v118
    v_fma_f32 v62, v62, v118, v118
    v_fma_f32 v63, v63, v118, v118
    v_rcp_f32 v48, v48
    v_rcp_f32 v49, v49
    v_rcp_f32 v50, v50
    v_rcp_f32 v51, v51
    v_rcp_f32 v52, v52
    v_rcp_f32 v53, v53
    v_rcp_f32 v54, v54
    v_rcp_f32 v55, v55
    v_rcp_f32 v56, v56
    v_rcp_f32 v57, v57
    v_rcp_f32 v58, v58
    v_rcp_f32 v59, v59
    v_rcp_f32 v60, v60
    v_rcp_f32 v61, v61
    v_rcp_f32 v62, v62
    v_rcp_f32 v63, v63
    v_mul_f32 v48, v48, v16
    v_mul_f32 v49, v49, v17
    v_mul_f32 v50, v50, v18
    v_mul_f32 v51, v51, v19
    v_mul_f32 v52, v52, v20
    v_mul_f32 v53, v53, v21
    v_mul_f32 v54, v54, v22
    v_mul_f32 v55, v55, v23
    v_mul_f32 v56, v56, v24
    v_mul_f32 v57, v57, v25
    v_mul_f32 v58, v58, v26
    v_mul_f32 v59, v59, v27
    v_mul_f32 v60, v60, v28
    v_mul_f32 v61, v61, v29
    v_mul_f32 v62, v62, v30
    v_mul_f32 v63, v63, v31
    s_cmp_lt_u32 s17, s34
    s_cbranch_scc1 P1_epiZ2
    v_cvt_pk_bf16_f32 v64, v48, v49
    v_cvt_pk_bf16_f32 v65, v50, v51
    v_cvt_pk_bf16_f32 v66, v52, v53
    v_cvt_pk_bf16_f32 v67, v54, v55
    v_cvt_pk_bf16_f32 v68, v56, v57
    v_cvt_pk_bf16_f32 v69, v58, v59
    v_cvt_pk_bf16_f32 v70, v60, v61
    v_cvt_pk_bf16_f32 v71, v62, v63
    s_add_u32 s26, s17, s14
    s_cmp_eq_u32 s26, 3
    global_store_dwordx4 v1, v[64:67], s[56:57] sc1
    global_store_dwordx4 v1, v[68:71], s[56:57] offset:1024 sc1
    s_cbranch_scc1 P1_zfin
P1_tail2:
    s_waitcnt vmcnt(3) lgkmcnt(0)
P1_tail:
    s_add_u32 s17, s17, 1
    s_mov_b64 s[56:57], s[58:59]
    s_mov_b64 s[58:59], s[60:61]
    s_mov_b64 s[60:61], s[62:63]
    s_add_u32 s26, s17, s16
    s_cmp_eq_u32 s17, 3
    s_cbranch_scc1 P1_last
    s_cmp_eq_u32 s26, 2
    s_cselect_b32 s26, s17, 0
    s_cmp_eq_u32 s26, 2
    s_cbranch_vccz P1_npre
    ds_read_b64_tr_b16 v[32:33], v4 offset:0
    ds_read_b64_tr_b16 v[34:35], v4 offset:512
    ds_read_b64_tr_b16 v[36:37], v4 offset:2048
    ds_read_b64_tr_b16 v[38:39], v4 offset:2560
    ds_read_b64_tr_b16 v[40:41], v4 offset:4096
    ds_read_b64_tr_b16 v[42:43], v4 offset:4608
    s_barrier
    s_cbranch_scc0 P1_blkD2
    s_branch P1_blkV2
P1_npre:
    s_barrier
    s_cbranch_scc0 P1_blkD
    s_branch P1_blkV
P1_last:
    s_lshl_b32 s26, s42, 6
    v_xor_b32 v4, s26, v4
    v_xor_b32 v112, s26, v112
    v_xor_b32 v113, s26, v113
    v_xor_b32 v114, s26, v114
    s_barrier
    s_branch P1_blkN
P1_getk:
    s_mul_i32 s26, s30, 3072
    s_add_u32 s26, s26, 139264
    v_add_u32 v5, s26, v1
    ds_read_b128 v[12:15], v5
    ds_read_b128 v[116:119], v5 offset:1024
    ds_read_b32 v120, v5 offset:2048
    s_branch P1_havek
P1_epiZ2:
    v_add_f32 v124, v124, v48
    v_fmac_f32 v126, v48, v48
    v_add_f32 v125, v125, v49
    v_fmac_f32 v127, v49, v49
    v_add_f32 v124, v124, v50
    v_fmac_f32 v126, v50, v50
    v_add_f32 v125, v125, v51
    v_fmac_f32 v127, v51, v51
    v_add_f32 v124, v124, v52
    v_fmac_f32 v126, v52, v52
    v_add_f32 v125, v125, v53
    v_fmac_f32 v127, v53, v53
    v_add_f32 v124, v124, v54
    v_fmac_f32 v126, v54, v54
    v_add_f32 v125, v125, v55
    v_fmac_f32 v127, v55, v55
    v_add_f32 v124, v124, v56
    v_fmac_f32 v126, v56, v56
    v_add_f32 v125, v125, v57
    v_fmac_f32 v127, v57, v57
    v_add_f32 v124, v124, v58
    v_fmac_f32 v126, v58, v58
    v_add_f32 v125, v125, v59
    v_fmac_f32 v127, v59, v59
    v_add_f32 v124, v124, v60
    v_fmac_f32 v126, v60, v60
    v_add_f32 v125, v125, v61
    v_fmac_f32 v127, v61, v61
    v_add_f32 v124, v124, v62
    v_fmac_f32 v126, v62, v62
    v_add_f32 v125, v125, v63
    v_fmac_f32 v127, v63, v63
    s_cmp_eq_u32 s17, 0
    s_cbranch_scc0 P1_st1
    v_cvt_pk_bf16_f32 v80, v48, v49
    v_cvt_pk_bf16_f32 v81, v50, v51
    v_cvt_pk_bf16_f32 v82, v52, v53
    v_cvt_pk_bf16_f32 v83, v54, v55
    v_cvt_pk_bf16_f32 v84, v56, v57
    v_cvt_pk_bf16_f32 v85, v58, v59
    v_cvt_pk_bf16_f32 v86, v60, v61
    v_cvt_pk_bf16_f32 v87, v62, v63
    s_cmp_eq_u32 s34, 1
    s_cbranch_scc1 P1_pub
    s_waitcnt vmcnt(1) lgkmcnt(0)
    s_branch P1_tail
P1_st1:
    v_cvt_pk_bf16_f32 v88, v48, v49
    v_cvt_pk_bf16_f32 v89, v50, v51
    v_cvt_pk_bf16_f32 v90, v52, v53
    v_cvt_pk_bf16_f32 v91, v54, v55
    v_cvt_pk_bf16_f32 v92, v56, v57
    v_cvt_pk_bf16_f32 v93, v58, v59
    v_cvt_pk_bf16_f32 v94, v60, v61
    v_cvt_pk_bf16_f32 v95, v62, v63
P1_pub:
    v_add_f32 v124, v124, v125
    v_add_f32 v126, v126, v127
    v_mov_b32 v48, v124
    v_mov_b32 v50, v126
    v_mov_b32 v49, s41
    v_mov_b32 v51, s41
    v_permlane32_swap_b32 v124, v48
    v_permlane32_swap_b32 v126, v50
    v_add_f32 v48, v124, v48
    v_add_f32 v50, v126, v50
    s_mov_b32 exec_hi, 0
    global_store_dwordx4 v1, v[48:51], s[64:65] sc1
    s_mov_b32 exec_hi, -1
    s_waitcnt vmcnt(2) lgkmcnt(0)
    s_branch P1_tail
P1_epiQK:
    s_cmp_eq_u32 s17, 0
    s_mov_b32 s26, 0x10000
    s_cbranch_scc1 P1_isq
    s_mov_b32 s26, 0x20000
    v_mov_b32 v116, v117
P1_isq:
    v_add_u32 v5, s26, v1
    v_mul_f32 v16, v16, v116
    v_mul_f32 v17, v17, v116
    v_mul_f32 v18, v18, v116
    v_mul_f32 v19, v19, v116
    v_mul_f32 v20, v20, v116
    v_mul_f32 v21, v21, v116
    v_mul_f32 v22, v22, v116
    v_mul_f32 v23, v23, v116
    v_mul_f32 v24, v24, v116
    v_mul_f32 v25, v25, v116
    v_mul_f32 v26, v26, v116
    v_mul_f32 v27, v27, v116
    v_mul_f32 v28, v28, v116
    v_mul_f32 v29, v29, v116
    v_mul_f32 v30, v30, v116
    v_mul_f32 v31, v31, v116
    v_cvt_pk_bf16_f32 v48, v16, v17
    v_cvt_pk_bf16_f32 v49, v18, v19
    v_cvt_pk_bf16_f32 v50, v20, v21
    v_cvt_pk_bf16_f32 v51, v22, v23
    v_cvt_pk_bf16_f32 v52, v24, v25
    v_cvt_pk_bf16_f32 v53, v26, v27
    v_cvt_pk_bf16_f32 v54, v28, v29
    v_cvt_pk_bf16_f32 v55, v30, v31
    global_store_dwordx4 v1, v[48:51], s[56:57] sc1
    global_store_dwordx4 v5, v[52:55], s[56:57] sc1
    s_branch P1_tail2
P1_blkV:
    ds_read_b64_tr_b16 v[32:33], v4 offset:0
    ds_read_b64_tr_b16 v[34:35], v4 offset:512
    ds_read_b64_tr_b16 v[36:37], v4 offset:2048
    ds_read_b64_tr_b16 v[38:39], v4 offset:2560
    ds_read_b64_tr_b16 v[40:41], v4 offset:4096
    ds_read_b64_tr_b16 v[42:43], v4 offset:4608
P1_blkV2:
    ds_read_b64_tr_b16 v[44:45], v4 offset:6144
    ds_read_b64_tr_b16 v[46:47], v4 offset:6656
    s_waitcnt lgkmcnt(6)
    v_mfma_f32_32x32x16_bf16 v[16:31], v[128:131], v[32:35], 0
    ds_read_b64_tr_b16 v[32:33], v4 offset:8192
    ds_read_b64_tr_b16 v[34:35], v4 offset:8704
    s_waitcnt lgkmcnt(6)
    v_mfma_f32_32x32x16_bf16 v[16:31], v[132:135], v[36:39], v[16:31]
    ds_read_b64_tr_b16 v[36:37], v4 offset:10240
    ds_read_b64_tr_b16 v[38:39], v4 offset:10752
    s_waitcnt lgkmcnt(6)
    v_mfma_f32_32x32x16_bf16 v[16:31], v[136:139], v[40:43], v[16:31]
    ds_read_b64_tr_b16 v[40:41], v4 offset:12288
    ds_read_b64_tr_b16 v[42:43], v4 offset:12800
    s_waitcnt lgkmcnt(6)
    v_mfma_f32_32x32x16_bf16 v[16:31], v[140:143], v[44:47], v[16:31]
    ds_read_b64_tr_b16 v[44:45], v4 offset:14336
    ds_read_b64_tr_b16 v[46:47], v4 offset:14848
    s_waitcnt lgkmcnt(6)
    v_mfma_f32_32x32x16_bf16 v[16:31], v[144:147], v[32:35], v[16:31]
    ds_read_b64_tr_b16 v[32:33], v112 offset:0
    ds_read_b64_tr_b16 v[34:35], v112 offset:512
    s_waitcnt lgkmcnt(6)
    v_mfma_f32_32x32x16_bf16 v[16:31], v[148:151], v[36:39], v[16:31]
    ds_read_b64_tr_b16 v[36:37], v112 offset:2048
    ds_read_b64_tr_b16 v[38:39], v112 offset:2560
    s_waitcnt lgkmcnt(6)
    v_mfma_f32_32x32x16_bf16 v[16:31], v[152:155], v[40:43], v[16:31]
    ds_read_b64_tr_b16 v[40:41], v112 offset:4096
    ds_read_b64_tr_b16 v[42:43], v112 offset:4608
    s_waitcnt lgkmcnt(6)
    v_mfma_f32_32x32x16_bf16 v[16:31], v[156:159], v[44:47], v[16:31]
    ds_read_b64_tr_b16 v[44:45], v112 offset:6144
    ds_read_b64_tr_b16 v[46:47], v112 offset:6656
    s_waitcnt lgkmcnt(6)
    v_mfma_f32_32x32x16_bf16 v[16:31], v[160:163], v[32:35], v[16:31]
    ds_read_b64_tr_b16 v[32:33], v112 offset:8192
    ds_read_b64_tr_b16 v[34:35], v112 offset:8704
    s_waitcnt lgkmcnt(6)
    v_mfma_f32_32x32x16_bf16 v[16:31], v[164:167], v[36:39], v[16:31]
    ds_read_b64_tr_b16 v[36:37], v112 offset:10240
    ds_read_b64_tr_b16 v[38:39], v112 offset:10752
    s_waitcnt lgkmcnt(6)
    v_mfma_f32_32x32x16_bf16 v[16:31], v[168:171], v[40:43], v[16:31]
    ds_read_b64_tr_b16 v[40:41], v112 offset:12288
    ds_read_b64_tr_b16 v[42:43], v112 offset:12800
    s_waitcnt lgkmcnt(6)
    v_mfma_f32_32x32x16_bf16 v[16:31], v[172:175], v[44:47], v[16:31]
    ds_read_b64_tr_b16 v[44:45], v112 offset:14336
    ds_read_b64_tr_b16 v[46:47], v112 offset:14848
    s_waitcnt lgkmcnt(6)
    v_mfma_f32_32x32x16_bf16 v[16:31], v[176:179], v[32:35], v[16:31]
    ds_read_b64_tr_b16 v[48:49], v113 offset:0
    ds_read_b64_tr_b16 v[50:51], v113 offset:512
    s_waitcnt lgkmcnt(6)
    v_mfma_f32_32x32x16_bf16 v[16:31], v[180:183], v[36:39], v[16:31]
    ds_read_b64_tr_b16 v[52:53], v113 offset:2048
    ds_read_b64_tr_b16 v[54:55], v113 offset:2560
    s_waitcnt lgkmcnt(6)
    v_mfma_f32_32x32x16_bf16 v[16:31], v[184:187], v[40:43], v[16:31]
    ds_read_b64_tr_b16 v[56:57], v113 offset:4096
    ds_read_b64_tr_b16 v[58:59], v113 offset:4608
    s_waitcnt lgkmcnt(6)
    v_mfma_f32_32x32x16_bf16 v[16:31], v[188:191], v[44:47], v[16:31]
    ds_read_b64_tr_b16 v[60:61], v113 offset:6144
    ds_read_b64_tr_b16 v[62:63], v113 offset:6656
    s_waitcnt lgkmcnt(6)
    v_mfma_f32_32x32x16_bf16 v[16:31], v[192:195], v[48:51], v[16:31]
    ds_read_b64_tr_b16 v[64:65], v113 offset:8192
    ds_read_b64_tr_b16 v[66:67], v113 offset:8704
    s_waitcnt lgkmcnt(6)
    v_mfma_f32_32x32x16_bf16 v[16:31], v[196:199], v[52:55], v[16:31]
    ds_read_b64_tr_b16 v[68:69], v113 offset:10240
    ds_read_b64_tr_b16 v[70:71], v113 offset:10752
    s_waitcnt lgkmcnt(6)
    v_mfma_f32_32x32x16_bf16 v[16:31], v[200:203], v[56:59], v[16:31]
    ds_read_b64_tr_b16 v[72:73], v113 offset:12288
    ds_read_b64_tr_b16 v[74:75], v113 offset:12800
    s_waitcnt lgkmcnt(6)
    v_mfma_f32_32x32x16_bf16 v[16:31], v[204:207], v[60:63], v[16:31]
    ds_read_b64_tr_b16 v[76:77], v113 offset:14336
    ds_read_b64_tr_b16 v[78:79], v113 offset:14848
    s_waitcnt lgkmcnt(6)
    v_mfma_f32_32x32x16_bf16 v[16:31], v[208:211], v[64:67], v[16:31]
    ds_read_b64_tr_b16 v[32:33], v114 offset:0
    ds_read_b64_tr_b16 v[34:35], v114 offset:512
    s_waitcnt lgkmcnt(6)
    v_mfma_f32_32x32x16_bf16 v[16:31], v[212:215], v[68:71], v[16:31]
    ds_read_b64_tr_b16 v[36:37], v114 offset:2048
    ds_read_b64_tr_b16 v[38:39], v114 offset:2560
    s_waitcnt lgkmcnt(6)
    v_mfma_f32_32x32x16_bf16 v[16:31], v[216:219], v[72:75], v[16:31]
    ds_read_b64_tr_b16 v[40:41], v114 offset:4096
    ds_read_b64_tr_b16 v[42:43], v114 offset:4608
    s_waitcnt lgkmcnt(6)
    v_mfma_f32_32x32x16_bf16 v[16:31], v[220:223], v[76:79], v[16:31]
    v_mfma_f32_16x16x32_bf16 v[100:103], v[96:99], v[48:51], 0
    v_mfma_f32_16x16x32_bf16 v[100:103], v[96:99], v[52:55], v[100:103]
    v_mfma_f32_16x16x32_bf16 v[100:103], v[96:99], v[56:59], v[100:103]
    v_mfma_f32_16x16x32_bf16 v[100:103], v[96:99], v[60:63], v[100:103]
    v_mfma_f32_16x16x32_bf16 v[100:103], v[96:99], v[64:67], v[100:103]
    v_mfma_f32_16x16x32_bf16 v[100:103], v[96:99], v[68:71], v[100:103]
    v_mfma_f32_16x16x32_bf16 v[100:103], v[96:99], v[72:75], v[100:103]
    v_mfma_f32_16x16x32_bf16 v[100:103], v[96:99], v[76:79], v[100:103]
    ds_read_b64_tr_b16 v[44:45], v114 offset:6144
    ds_read_b64_tr_b16 v[46:47], v114 offset:6656
    ds_read_b64_tr_b16 v[48:49], v114 offset:8192
    ds_read_b64_tr_b16 v[50:51], v114 offset:8704
    ds_read_b64_tr_b16 v[52:53], v114 offset:10240
    ds_read_b64_tr_b16 v[54:55], v114 offset:10752
    s_waitcnt lgkmcnt(10)
    v_mfma_f32_32x32x16_bf16 v[16:31], v[224:227], v[32:35], v[16:31]
    ds_read_b64_tr_b16 v[56:57], v114 offset:12288
    ds_read_b64_tr_b16 v[58:59], v114 offset:12800
    ds_read_b64_tr_b16 v[60:61], v114 offset:14336
    ds_read_b64_tr_b16 v[62:63], v114 offset:14848
    s_waitcnt lgkmcnt(12)
    v_mfma_f32_32x32x16_bf16 v[16:31], v[228:231], v[36:39], v[16:31]
    v_cvt_pk_bf16_f32 v101, v100, v100
    v_and_b32 v101, 0xffff0000, v101
    v_sub_f32 v100, v100, v101
    v_cvt_pk_bf16_f32 v102, v101, v100
    v_lshrrev_b32 v103, 16, v101
    ds_write_b64 v10, v[102:103]
    s_waitcnt lgkmcnt(11)
    v_mfma_f32_32x32x16_bf16 v[16:31], v[232:235], v[40:43], v[16:31]
    v_add_u32 v10, 0x800, v10
    v_xor_b32 v4, 0x10000, v4
    v_xor_b32 v112, 0x10000, v112
    v_xor_b32 v113, 0x10000, v113
    v_xor_b32 v114, 0x10000, v114
    s_waitcnt lgkmcnt(9)
    v_mfma_f32_32x32x16_bf16 v[16:31], v[236:239], v[44:47], v[16:31]
    s_setprio 2
    s_waitcnt lgkmcnt(0)
    s_barrier
    ds_read_b128 v[32:35], v8
    v_mfma_f32_32x32x16_bf16 v[16:31], v[240:243], v[48:51], v[16:31]
    v_mfma_f32_32x32x16_bf16 v[16:31], v[244:247], v[52:55], v[16:31]
    v_mfma_f32_32x32x16_bf16 v[16:31], v[248:251], v[56:59], v[16:31]
    v_mfma_f32_32x32x16_bf16 v[16:31], v[252:255], v[60:63], v[16:31]
    ds_read_b128 v[100:103], v9 offset:0
    ds_read_b128 v[104:107], v9 offset:32
    ds_read_b128 v[108:111], v9 offset:64
    ds_read_b128 v[112:115], v9 offset:96
    s_waitcnt lgkmcnt(4)
    v_mfma_f32_32x32x16_bf16 v[16:31], v[12:15], v[32:35], v[16:31]
    s_setprio 0
    s_nop 9
    s_waitcnt lgkmcnt(0)
    v_mul_f32 v16, v16, v100
    v_mul_f32 v17, v17, v101
    v_mul_f32 v18, v18, v102
    v_mul_f32 v19, v19, v103
    v_mul_f32 v20, v20, v104
    v_mul_f32 v21, v21, v105
    v_mul_f32 v22, v22, v106
    v_mul_f32 v23, v23, v107
    v_mul_f32 v24, v24, v108
    v_mul_f32 v25, v25, v109
    v_mul_f32 v26, v26, v110
    v_mul_f32 v27, v27, v111
    v_mul_f32 v28, v28, v112
    v_mul_f32 v29, v29, v113
    v_mul_f32 v30, v30, v114
    v_mul_f32 v31, v31, v115
    v_cvt_pk_bf16_f32 v48, v16, v17
    v_cvt_pk_bf16_f32 v49, v18, v19
    v_cvt_pk_bf16_f32 v50, v20, v21
    v_cvt_pk_bf16_f32 v51, v22, v23
    v_cvt_pk_bf16_f32 v52, v24, v25
    v_cvt_pk_bf16_f32 v53, v26, v27
    v_cvt_pk_bf16_f32 v54, v28, v29
    v_cvt_pk_bf16_f32 v55, v30, v31
    global_store_dwordx4 v123, v[48:51], s[56:57] offset:1024 sc1
    global_store_dwordx4 v123, v[52:55], s[56:57] offset:1280 sc1
    s_cbranch_vccnz PH2
    s_barrier
    s_branch PH2
P1_gstart:
    s_cbranch_vccnz P1_gs2
    ds_read_b64 v[122:123], v111
    s_and_b32 s26, s2, 7
    s_lshl_b32 s26, s26, 7
    s_add_u32 s26, s26, 29163520
    v_and_b32 v7, 15, v0
    v_lshl_add_u32 v7, v7, 2, s26
    global_load_dword v121, v7, s[4:5] sc1
    s_branch P1_gret
P1_gs2:
    global_load_dwordx4 v[128:131], v110, s[80:81] offset:-4096 sc1
    global_load_dwordx4 v[132:135], v110, s[80:81] offset:0 sc1
    global_load_dwordx4 v[136:139], v110, s[82:83] offset:-4096 sc1
    global_load_dwordx4 v[140:143], v110, s[82:83] offset:0 sc1
    global_load_dwordx4 v[144:147], v110, s[84:85] offset:-4096 sc1
    global_load_dwordx4 v[148:151], v110, s[84:85] offset:0 sc1
    global_load_dwordx4 v[152:155], v110, s[86:87] offset:-4096 sc1
    global_load_dwordx4 v[156:159], v110, s[86:87] offset:0 sc1
    s_branch P1_gret
P1_zfin:
    s_cbranch_vccz P1_norm
    s_waitcnt vmcnt(2)
P1_gchk:
    v_mov_b32 v10, 0
    v_xor_b32 v16, s41, v129
    v_or_b32 v10, v10, v16
    v_xor_b32 v16, s41, v131
    v_or_b32 v10, v10, v16
    v_xor_b32 v16, s41, v133
    v_or_b32 v10, v10, v16
    v_xor_b32 v16, s41, v135
    v_or_b32 v10, v10, v16
    v_xor_b32 v16, s41, v137
    v_or_b32 v10, v10, v16
    v_xor_b32 v16, s41, v139
    v_or_b32 v10, v10, v16
    v_xor_b32 v16, s41, v141
    v_or_b32 v10, v10, v16
    v_xor_b32 v16, s41, v143
    v_or_b32 v10, v10, v16
    v_xor_b32 v16, s41, v145
    v_or_b32 v10, v10, v16
    v_xor_b32 v16, s41, v147
    v_or_b32 v10, v10, v16
    v_xor_b32 v16, s41, v149
    v_or_b32 v10, v10, v16
    v_xor_b32 v16, s41, v151
    v_or_b32 v10, v10, v16
    v_xor_b32 v16, s41, v153
    v_or_b32 v10, v10, v16
    v_xor_b32 v16, s41, v155
    v_or_b32 v10, v10, v16
    v_xor_b32 v16, s41, v157
    v_or_b32 v10, v10, v16
    v_xor_b32 v16, s41, v159
    v_or_b32 v10, v10, v16
    v_cmp_ne_u32 s[26:27], 0, v10
    s_nop 0
    s_cmp_eq_u64 s[26:27], 0
    s_cbranch_scc1 P1_gok
    global_load_dwordx4 v[128:131], v110, s[80:81] offset:-4096 sc1
    global_load_dwordx4 v[132:135], v110, s[80:81] offset:0 sc1
    global_load_dwordx4 v[136:139], v110, s[82:83] offset:-4096 sc1
    global_load_dwordx4 v[140:143], v110, s[82:83] offset:0 sc1
    global_load_dwordx4 v[144:147], v110, s[84:85] offset:-4096 sc1
    global_load_dwordx4 v[148:151], v110, s[84:85] offset:0 sc1
    global_load_dwordx4 v[152:155], v110, s[86:87] offset:-4096 sc1
    global_load_dwordx4 v[156:159], v110, s[86:87] offset:0 sc1
    s_waitcnt vmcnt(0)
    s_sub_u32 s98, s98, 1
    s_cmp_gt_i32 s98, 0
    s_cbranch_scc1 P1_gchk
P1_gok:
    v_add_f32 v128, v128, v132
    v_add_f32 v130, v130, v134
    v_add_f32 v128, v128, v136
    v_add_f32 v130, v130, v138
    v_add_f32 v128, v128, v140
    v_add_f32 v130, v130, v142
    v_add_f32 v128, v128, v144
    v_add_f32 v130, v130, v146
    v_add_f32 v128, v128, v148
    v_add_f32 v130, v130, v150
    v_add_f32 v128, v128, v152
    v_add_f32 v130, v130, v154
    v_add_f32 v128, v128, v156
    v_add_f32 v130, v130, v158
    v_mov_b32 v122, v128
    v_mov_b32 v123, v130
    s_nop 1
    v_permlane32_swap_b32 v128, v122
    v_permlane32_swap_b32 v130, v123
    v_add_f32 v122, v122, v128
    v_add_f32 v123, v123, v130
    v_mul_f32 v122, 0x3a924925, v122
    v_mul_f32 v123, 0x3a924925, v123
    v_fma_f32 v123, -v122, v122, v123
    v_max_f32 v123, 0, v123
    v_add_f32 v123, 0x3727c5ac, v123
    v_rsq_f32 v123, v123
    s_nop 0
    v_mul_f32 v122, v122, v123
    ds_write_b64 v111, v[122:123]
    s_waitcnt lgkmcnt(0)
    s_barrier
P1_norm:
    s_waitcnt lgkmcnt(0)
    v_lshlrev_b32 v72, 16, v80
    v_and_b32 v73, 0xffff0000, v80
    v_fma_f32 v72, v72, v123, -v122
    v_fma_f32 v73, v73, v123, -v122
    v_cvt_pk_bf16_f32 v80, v72, v73
    v_lshlrev_b32 v74, 16, v81
    v_and_b32 v75, 0xffff0000, v81
    v_fma_f32 v74, v74, v123, -v122
    v_fma_f32 v75, v75, v123, -v122
    v_cvt_pk_bf16_f32 v81, v74, v75
    ds_write_b64 v108, v[80:81] offset:0
    v_lshlrev_b32 v72, 16, v82
    v_and_b32 v73, 0xffff0000, v82
    v_fma_f32 v72, v72, v123, -v122
    v_fma_f32 v73, v73, v123, -v122
    v_cvt_pk_bf16_f32 v82, v72, v73
    v_lshlrev_b32 v74, 16, v83
    v_and_b32 v75, 0xffff0000, v83
    v_fma_f32 v74, v74, v123, -v122
    v_fma_f32 v75, v75, v123, -v122
    v_cvt_pk_bf16_f32 v83, v74, v75
    ds_write_b64 v108, v[82:83] offset:16
    v_lshlrev_b32 v72, 16, v84
    v_and_b32 v73, 0xffff0000, v84
    v_fma_f32 v72, v72, v123, -v122
    v_fma_f32 v73, v73, v123, -v122
    v_cvt_pk_bf16_f32 v84, v72, v73
    v_lshlrev_b32 v74, 16, v85
    v_and_b32 v75, 0xffff0000, v85
    v_fma_f32 v74, v74, v123, -v122
    v_fma_f32 v75, v75, v123, -v122
    v_cvt_pk_bf16_f32 v85, v74, v75
    ds_write_b64 v108, v[84:85] offset:32
    v_lshlrev_b32 v72, 16, v86
    v_and_b32 v73, 0xffff0000, v86
    v_fma_f32 v72, v72, v123, -v122
    v_fma_f32 v73, v73, v123, -v122
    v_cvt_pk_bf16_f32 v86, v72, v73
    v_lshlrev_b32 v74, 16, v87
    v_and_b32 v75, 0xffff0000, v87
    v_fma_f32 v74, v74, v123, -v122
    v_fma_f32 v75, v75, v123, -v122
    v_cvt_pk_bf16_f32 v87, v74, v75
    ds_write_b64 v108, v[86:87] offset:48
    ds_read_b64_tr_b16 v[32:33], v109 offset:0
    ds_read_b64_tr_b16 v[34:35], v109 offset:288
    ds_read_b64_tr_b16 v[36:37], v109 offset:1152
    ds_read_b64_tr_b16 v[38:39], v109 offset:1440
    s_cmp_eq_u32 s34, 2
    s_cbranch_scc0 P1_n1
    v_lshlrev_b32 v72, 16, v88
    v_and_b32 v73, 0xffff0000, v88
    v_fma_f32 v72, v72, v123, -v122
    v_fma_f32 v73, v73, v123, -v122
    v_cvt_pk_bf16_f32 v88, v72, v73
    v_lshlrev_b32 v74, 16, v89
    v_and_b32 v75, 0xffff0000, v89
    v_fma_f32 v74, v74, v123, -v122
    v_fma_f32 v75, v75, v123, -v122
    v_cvt_pk_bf16_f32 v89, v74, v75
    ds_write_b64 v108, v[88:89] offset:2304
    v_lshlrev_b32 v72, 16, v90
    v_and_b32 v73, 0xffff0000, v90
    v_fma_f32 v72, v72, v123, -v122
    v_fma_f32 v73, v73, v123, -v122
    v_cvt_pk_bf16_f32 v90, v72, v73
    v_lshlrev_b32 v74, 16, v91
    v_and_b32 v75, 0xffff0000, v91
    v_fma_f32 v74, v74, v123, -v122
    v_fma_f32 v75, v75, v123, -v122
    v_cvt_pk_bf16_f32 v91, v74, v75
    ds_write_b64 v108, v[90:91] offset:2320
    v_lshlrev_b32 v72, 16, v92
    v_and_b32 v73, 0xffff0000, v92
    v_fma_f32 v72, v72, v123, -v122
    v_fma_f32 v73, v73, v123, -v122
    v_cvt_pk_bf16_f32 v92, v72, v73
    v_lshlrev_b32 v74, 16, v93
    v_and_b32 v75, 0xffff0000, v93
    v_fma_f32 v74, v74, v123, -v122
    v_fma_f32 v75, v75, v123, -v122
    v_cvt_pk_bf16_f32 v93, v74, v75
    ds_write_b64 v108, v[92:93] offset:2336
    v_lshlrev_b32 v72, 16, v94
    v_and_b32 v73, 0xffff0000, v94
    v_fma_f32 v72, v72, v123, -v122
    v_fma_f32 v73, v73, v123, -v122
    v_cvt_pk_bf16_f32 v94, v72, v73
    v_lshlrev_b32 v74, 16, v95
    v_and_b32 v75, 0xffff0000, v95
    v_fma_f32 v74, v74, v123, -v122
    v_fma_f32 v75, v75, v123, -v122
    v_cvt_pk_bf16_f32 v95, v74, v75
    ds_write_b64 v108, v[94:95] offset:2352
    ds_read_b64_tr_b16 v[40:41], v109 offset:2304
    ds_read_b64_tr_b16 v[42:43], v109 offset:2592
    ds_read_b64_tr_b16 v[44:45], v109 offset:3456
    ds_read_b64_tr_b16 v[46:47], v109 offset:3744
    s_waitcnt lgkmcnt(0)
    global_store_dwordx4 v1, v[40:43], s[78:79] offset:0 sc1
    global_store_dwordx4 v1, v[44:47], s[78:79] offset:1024 sc1
P1_n1:
    s_waitcnt lgkmcnt(0)
    global_store_dwordx4 v1, v[32:35], s[88:89] offset:0 sc1
    global_store_dwordx4 v1, v[36:39], s[88:89] offset:1024 sc1
PH2:
    s_mov_b32 s60, s41
    s_andn2_b32 s63, s16, s14
    s_mov_b32 s59, s16
    s_setprio 0
    s_and_b32 s30, s2, 7
    s_lshr_b32 s31, s2, 3
    v_lshlrev_b32 v1, 4, v0
    s_lshl_b32 s61, s30, 2
    s_lshr_b32 s26, s31, 3
    s_add_u32 s61, s61, s26
    s_and_b32 s62, s31, 7
    s_mov_b32 s98, 100000000
    s_waitcnt lgkmcnt(0)
    s_cmp_ge_u32 s13, 4
    s_cbranch_scc1 P2_gemm
    s_lshl_b32 s14, s30, 2
    s_lshr_b32 s26, s31, 3
    s_add_u32 s14, s14, s26
    s_and_b32 s15, s31, 7
    s_lshl_b32 s15, s15, 3
    s_lshr_b32 s26, s13, 1
    s_lshl_b32 s26, s26, 2
    s_add_u32 s15, s15, s26
    s_and_b32 s16, s13, 1
    s_lshl_b32 s26, s14, 6
    s_add_u32 s27, s26, s15
    s_lshl_b32 s27, s27, 10
    s_add_u32 s27, s27, 2097152
    s_add_u32 s24, s4, s27
    s_addc_u32 s25, s5, 0
    s_cmp_eq_u32 s63, 0
    s_cbranch_scc1 A_q
    s_waitcnt vmcnt(4)
    v_cmp_ne_u32 vcc, s60, v121
    s_cbranch_vccz A_go
    s_branch A_p
A_q:
    s_waitcnt vmcnt(0)
    s_barrier
    s_barrier
    v_mov_b32 v4, 149584
    s_cmp_eq_u32 s13, 0
    s_cbranch_scc1 A_p
A_lw:
    ds_read_b32 v3, v4
    s_waitcnt lgkmcnt(0)
    v_readfirstlane_b32 s27, v3
    s_nop 0
    s_cmp_ge_u32 s27, 1
    s_cbranch_scc1 A_lw_d
    s_sleep 4
    s_sub_u32 s98, s98, 1
    s_cmp_gt_i32 s98, 0
    s_cbranch_scc1 A_lw
A_lw_d:
    s_branch A_go
A_p:
    s_lshl_b32 s27, s30, 7
    s_add_u32 s27, s27, 29163520
    v_lshl_add_u32 v2, v0, 2, s27
    s_mov_b64 exec, 65535
A_pkv:
    global_load_dword v3, v2, s[4:5] sc1
    s_waitcnt vmcnt(0)
    v_cmp_ne_u32 vcc, s60, v3
    s_cbranch_vccz A_pkv_d
    s_sleep 8
    s_sub_u32 s98, s98, 1
    s_cmp_gt_i32 s98, 0
    s_cbranch_scc1 A_pkv
A_pkv_d:
    s_mov_b64 exec, -1
    s_cmp_eq_u32 s63, 0
    s_cbranch_scc0 A_go
    v_mov_b32 v3, 1
    ds_write_b32 v4, v3
A_go:
    s_lshl_b32 s27, s16, 11
    v_xor_b32 v2, s27, v1
    v_xor_b32 v3, 0x800, v2
    global_load_dwordx4 v[8:11], v2, s[24:25] offset:0 sc1
    global_load_dwordx4 v[12:15], v2, s[24:25] offset:1024 sc1
    global_load_dwordx4 v[16:19], v3, s[24:25] offset:0 sc1
    global_load_dwordx4 v[20:23], v3, s[24:25] offset:1024 sc1
    s_lshl_b32 s27, s16, 5
    s_add_u32 s26, s26, s27
    s_lshl_b32 s26, s26, 11
    s_add_u32 s26, s26, 4198400
    s_add_u32 s20, s4, s26
    s_addc_u32 s21, s5, 0
    s_mov_b32 s44, 0
    s_mov_b32 s45, 0
A_restart:
    global_load_dwordx4 v[24:27], v1, s[20:21] offset:-4096 sc1
    global_load_dwordx4 v[28:31], v1, s[20:21] offset:-2048 sc1
    s_mov_b32 s40, 0xffff
    s_mov_b32 s41, 0xffff
    s_mov_b32 s46, 0x3f803f80
    s_mov_b32 s47, 0x3f803f80
    s_not_b64 exec, s[40:41]
    v_mov_b64 v[40:41], 0
    v_mov_b64 v[42:43], 0
    v_mov_b64 v[44:45], 0
    v_mov_b64 v[46:47], 0
    v_mov_b64 v[48:49], 0
    v_mov_b64 v[50:51], 0
    v_mov_b64 v[52:53], 0
    v_mov_b64 v[54:55], 0
    v_mov_b64 v[56:57], 0
    v_mov_b64 v[58:59], 0
    v_mov_b64 v[60:61], 0
    v_mov_b64 v[62:63], 0
    v_mov_b64 v[64:65], 0
    v_mov_b64 v[66:67], 0
    v_mov_b64 v[68:69], 0
    v_mov_b64 v[70:71], 0
    s_mov_b32 exec_lo, 0x110000
    s_mov_b32 exec_hi, 0x110000
    v_mov_b64 v[40:41], s[46:47]
    v_mov_b64 v[42:43], s[46:47]
    v_mov_b64 v[44:45], s[46:47]
    v_mov_b64 v[46:47], s[46:47]
    v_mov_b64 v[48:49], s[46:47]
    v_mov_b64 v[50:51], s[46:47]
    v_mov_b64 v[52:53], s[46:47]
    v_mov_b64 v[54:55], s[46:47]
    v_mov_b64 v[56:57], s[46:47]
    v_mov_b64 v[58:59], s[46:47]
    v_mov_b64 v[60:61], s[46:47]
    v_mov_b64 v[62:63], s[46:47]
    v_mov_b64 v[64:65], s[46:47]
    v_mov_b64 v[66:67], s[46:47]
    v_mov_b64 v[68:69], s[46:47]
    v_mov_b64 v[70:71], s[46:47]
    s_mov_b64 exec, s[40:41]
    global_load_dwordx4 v[40:43], v1, s[20:21] offset:-3072 sc1
    global_load_dwordx4 v[44:47], v1, s[20:21] offset:-2816 sc1
    global_load_dwordx4 v[48:51], v1, s[20:21] offset:-1024 sc1
    global_load_dwordx4 v[52:55], v1, s[20:21] offset:-768 sc1
    v_mov_b64 v[64:65], 0
    v_mov_b64 v[66:67], 0
    v_mov_b64 v[68:69], 0
    v_mov_b64 v[70:71], 0
    s_mov_b64 exec, -1
    global_load_dwordx4 v[32:35], v1, s[20:21] offset:0 sc1
    s_mov_b64 exec, s[40:41]
    global_load_dwordx4 v[56:59], v1, s[20:21] offset:1024 sc1
    global_load_dwordx4 v[60:63], v1, s[20:21] offset:1280 sc1
    s_mov_b64 exec, -1
    global_load_dwordx4 v[36:39], v1, s[20:21] offset:2048 sc1
    s_add_u32 s24, s20, 7168
    s_addc_u32 s25, s21, 0
    s_mov_b64 s[42:43], 0
    v_mov_b64 v[184:185], 0
    v_mov_b64 v[186:187], 0
    v_mov_b64 v[188:189], 0
    v_mov_b64 v[190:191], 0
    v_mov_b64 v[192:193], 0
    v_mov_b64 v[200:201], 0
    v_mov_b64 v[202:203], 0
    v_mov_b64 v[204:205], 0
    v_mov_b64 v[206:207], 0
    v_mov_b64 v[208:209], 0
    v_mov_b64 v[216:217], 0
    v_mov_b64 v[218:219], 0
    v_mov_b64 v[220:221], 0
    v_mov_b64 v[222:223], 0
    v_mov_b64 v[224:225], 0
    v_mov_b64 v[232:233], 0
    v_mov_b64 v[234:235], 0
    v_mov_b64 v[236:237], 0
    v_mov_b64 v[238:239], 0
    v_mov_b64 v[240:241], 0
    v_mov_b64 v[80:81], 0
    v_mov_b64 v[82:83], 0
    v_mov_b64 v[84:85], 0
    v_mov_b64 v[86:87], 0
    v_mov_b32 v6, 0x7b800000
    s_cmp_lg_u32 s44, 0
    s_cbranch_scc1 A_setC
    s_cmp_eq_u32 s63, 0
    s_cbranch_scc1 A_m
    s_waitcnt vmcnt(14)
    s_barrier
    s_barrier
A_m:
    s_waitcnt vmcnt(8)
    v_mfma_f32_32x32x16_bf16 v[120:135], v[24:27], v[8:11], 0
    v_mfma_f32_32x32x16_bf16 v[136:151], v[28:31], v[8:11], 0
    v_mfma_f32_32x32x16_bf16 v[152:167], v[24:27], v[12:15], 0
    v_mfma_f32_32x32x16_bf16 v[168:183], v[28:31], v[12:15], 0
    s_nop 11
    v_max3_f32 v248, v120, v121, v122
    v_max_f32 v248, v248, v135
    v_max3_f32 v248, v248, v123, v124
    v_max3_f32 v248, v248, v125, v126
    v_max3_f32 v248, v248, v127, v128
    v_max3_f32 v248, v248, v129, v130
    v_max3_f32 v248, v248, v131, v132
    v_max3_f32 v248, v248, v133, v134
    v_max3_f32 v248, v248, v136, v137
    v_max3_f32 v248, v248, v138, v139
    v_max3_f32 v248, v248, v140, v141
    v_max3_f32 v248, v248, v142, v143
    v_max3_f32 v248, v248, v144, v145
    v_max3_f32 v248, v248, v146, v147
    v_max3_f32 v248, v248, v148, v149
    v_max3_f32 v248, v248, v150, v151
    v_max3_f32 v249, v152, v153, v154
    v_max_f32 v249, v249, v167
    v_max3_f32 v249, v249, v155, v156
    v_max3_f32 v249, v249, v157, v158
    v_max3_f32 v249, v249, v159, v160
    v_max3_f32 v249, v249, v161, v162
    v_max3_f32 v249, v249, v163, v164
    v_max3_f32 v249, v249, v165, v166
    v_max3_f32 v249, v249, v168, v169
    v_max3_f32 v249, v249, v170, v171
    v_max3_f32 v249, v249, v172, v173
    v_max3_f32 v249, v249, v174, v175
    v_max3_f32 v249, v249, v176, v177
    v_max3_f32 v249, v249, v178, v179
    v_max3_f32 v249, v249, v180, v181
    v_max3_f32 v249, v249, v182, v183
    v_mfma_f32_32x32x16_bf16 v[120:135], v[24:27], v[16:19], 0
    v_mfma_f32_32x32x16_bf16 v[136:151], v[28:31], v[16:19], 0
    v_mfma_f32_32x32x16_bf16 v[152:167], v[24:27], v[20:23], 0
    v_mfma_f32_32x32x16_bf16 v[168:183], v[28:31], v[20:23], 0
    s_nop 11
    v_max3_f32 v250, v120, v121, v122
    v_max_f32 v250, v250, v135
    v_max3_f32 v250, v250, v123, v124
    v_max3_f32 v250, v250, v125, v126
    v_max3_f32 v250, v250, v127, v128
    v_max3_f32 v250, v250, v129, v130
    v_max3_f32 v250, v250, v131, v132
    v_max3_f32 v250, v250, v133, v134
    v_max3_f32 v250, v250, v136, v137
    v_max3_f32 v250, v250, v138, v139
    v_max3_f32 v250, v250, v140, v141
    v_max3_f32 v250, v250, v142, v143
    v_max3_f32 v250, v250, v144, v145
    v_max3_f32 v250, v250, v146, v147
    v_max3_f32 v250, v250, v148, v149
    v_max3_f32 v250, v250, v150, v151
    v_max3_f32 v251, v152, v153, v154
    v_max_f32 v251, v251, v167
    v_max3_f32 v251, v251, v155, v156
    v_max3_f32 v251, v251, v157, v158
    v_max3_f32 v251, v251, v159, v160
    v_max3_f32 v251, v251, v161, v162
    v_max3_f32 v251, v251, v163, v164
    v_max3_f32 v251, v251, v165, v166
    v_max3_f32 v251, v251, v168, v169
    v_max3_f32 v251, v251, v170, v171
    v_max3_f32 v251, v251, v172, v173
    v_max3_f32 v251, v251, v174, v175
    v_max3_f32 v251, v251, v176, v177
    v_max3_f32 v251, v251, v178, v179
    v_max3_f32 v251, v251, v180, v181
    v_max3_f32 v251, v251, v182, v183
A_setC:
    v_mov_b32 v252, v248
    v_mov_b32 v253, v249
    v_mov_b32 v254, v250
    v_mov_b32 v255, v251
    s_nop 0
    v_permlane32_swap_b32 v248, v252
    v_permlane32_swap_b32 v249, v253
    v_permlane32_swap_b32 v250, v254
    v_permlane32_swap_b32 v251, v255
    v_max_f32 v248, v248, v252
    v_max_f32 v249, v249, v253
    v_max_f32 v250, v250, v254
    v_max_f32 v251, v251, v255
    v_sub_f32 v120, 0xc2c80000, v248
    v_mov_b32 v121, v120
    v_mov_b64 v[122:123], v[120:121]
    v_mov_b64 v[124:125], v[120:121]
    v_mov_b64 v[126:127], v[120:121]
    v_mov_b64 v[128:129], v[120:121]
    v_mov_b64 v[130:131], v[120:121]
    v_mov_b64 v[132:133], v[120:121]
    v_mov_b64 v[134:135], v[120:121]
    v_sub_f32 v136, 0xc2c80000, v249
    v_mov_b32 v137, v136
    v_mov_b64 v[138:139], v[136:137]
    v_mov_b64 v[140:141], v[136:137]
    v_mov_b64 v[142:143], v[136:137]
    v_mov_b64 v[144:145], v[136:137]
    v_mov_b64 v[146:147], v[136:137]
    v_mov_b64 v[148:149], v[136:137]
    v_mov_b64 v[150:151], v[136:137]
    v_sub_f32 v152, 0xc2c80000, v250
    v_mov_b32 v153, v152
    v_mov_b64 v[154:155], v[152:153]
    v_mov_b64 v[156:157], v[152:153]
    v_mov_b64 v[158:159], v[152:153]
    v_mov_b64 v[160:161], v[152:153]
    v_mov_b64 v[162:163], v[152:153]
    v_mov_b64 v[164:165], v[152:153]
    v_mov_b64 v[166:167], v[152:153]
    v_sub_f32 v168, 0xc2c80000, v251
    v_mov_b32 v169, v168
    v_mov_b64 v[170:171], v[168:169]
    v_mov_b64 v[172:173], v[168:169]
    v_mov_b64 v[174:175], v[168:169]
    v_mov_b64 v[176:177], v[168:169]
    v_mov_b64 v[178:179], v[168:169]
    v_mov_b64 v[180:181], v[168:169]
    v_mov_b64 v[182:183], v[168:169]
    s_waitcnt vmcnt(6)
    s_mov_b32 s17, 8
    v_mfma_f32_32x32x16_bf16 v[88:103], v[24:27], v[8:11], v[120:135]
    s_nop 11
.p2align 6
A_loop:
    v_exp_f32 v88, v88
    v_exp_f32 v89, v89
    v_mfma_f32_32x32x16_bf16 v[232:247], v[68:71], v[84:87], v[232:247]
    s_mov_b64 exec, s[40:41]
    global_load_dwordx4 v[64:67], v1, s[24:25] offset:-4096 sc1
    global_load_dwordx4 v[68:71], v1, s[24:25] offset:-3840 sc1
    s_mov_b64 exec, -1
    v_exp_f32 v90, v90
    v_exp_f32 v91, v91
    v_exp_f32 v92, v92
    v_exp_f32 v93, v93
    v_mfma_f32_32x32x16_bf16 v[104:119], v[24:27], v[12:15], v[136:151]
    v_exp_f32 v94, v94
    v_exp_f32 v95, v95
    v_cvt_pk_bf16_f32 v72, v88, v89
    v_cvt_pk_bf16_f32 v73, v90, v91
    v_cvt_pk_bf16_f32 v74, v92, v93
    v_cvt_pk_bf16_f32 v75, v94, v95
    v_exp_f32 v96, v96
    v_exp_f32 v97, v97
    v_mfma_f32_32x32x16_bf16 v[184:199], v[40:43], v[72:75], v[184:199]
    v_exp_f32 v98, v98
    v_exp_f32 v99, v99
    v_exp_f32 v100, v100
    v_exp_f32 v101, v101
    v_exp_f32 v102, v102
    v_exp_f32 v103, v103
    v_cvt_pk_bf16_f32 v76, v96, v97
    v_cvt_pk_bf16_f32 v77, v98, v99
    v_cvt_pk_bf16_f32 v78, v100, v101
    v_cvt_pk_bf16_f32 v79, v102, v103
    v_exp_f32 v104, v104
    v_exp_f32 v105, v105
    v_mfma_f32_32x32x16_bf16 v[184:199], v[44:47], v[76:79], v[184:199]
    v_exp_f32 v106, v106
    v_exp_f32 v107, v107
    v_exp_f32 v108, v108
    v_exp_f32 v109, v109
    v_mfma_f32_32x32x16_bf16 v[88:103], v[24:27], v[16:19], v[152:167]
    v_exp_f32 v110, v110
    v_exp_f32 v111, v111
    v_cvt_pk_bf16_f32 v80, v104, v105
    v_cvt_pk_bf16_f32 v81, v106, v107
    v_cvt_pk_bf16_f32 v82, v108, v109
    v_cvt_pk_bf16_f32 v83, v110, v111
    v_exp_f32 v112, v112
    v_exp_f32 v113, v113
    v_mfma_f32_32x32x16_bf16 v[200:215], v[40:43], v[80:83], v[200:215]
    v_exp_f32 v114, v114
    v_exp_f32 v115, v115
    v_exp_f32 v116, v116
    v_exp_f32 v117, v117
    v_exp_f32 v118, v118
    v_exp_f32 v119, v119
    v_cvt_pk_bf16_f32 v84, v112, v113
    v_cvt_pk_bf16_f32 v85, v114, v115
    v_cvt_pk_bf16_f32 v86, v116, v117
    v_cvt_pk_bf16_f32 v87, v118, v119
    v_exp_f32 v88, v88
    v_exp_f32 v89, v89
    v_mfma_f32_32x32x16_bf16 v[200:215], v[44:47], v[84:87], v[200:215]
    v_exp_f32 v90, v90
    v_exp_f32 v91, v91
    v_exp_f32 v92, v92
    v_exp_f32 v93, v93
    v_mfma_f32_32x32x16_bf16 v[104:119], v[24:27], v[20:23], v[168:183]
    v_exp_f32 v94, v94
    v_exp_f32 v95, v95
    v_cvt_pk_bf16_f32 v72, v88, v89
    v_cvt_pk_bf16_f32 v73, v90, v91
    v_cvt_pk_bf16_f32 v74, v92, v93
    v_cvt_pk_bf16_f32 v75, v94, v95
    v_exp_f32 v96, v96
    v_exp_f32 v97, v97
    v_mfma_f32_32x32x16_bf16 v[216:231], v[40:43], v[72:75], v[216:231]
    v_exp_f32 v98, v98
    v_exp_f32 v99, v99
    v_exp_f32 v100, v100
    v_exp_f32 v101, v101
    v_exp_f32 v102, v102
    v_exp_f32 v103, v103
    v_cvt_pk_bf16_f32 v76, v96, v97
    v_cvt_pk_bf16_f32 v77, v98, v99
    v_cvt_pk_bf16_f32 v78, v100, v101
    v_cvt_pk_bf16_f32 v79, v102, v103
    v_exp_f32 v104, v104
    v_exp_f32 v105, v105
    v_mfma_f32_32x32x16_bf16 v[216:231], v[44:47], v[76:79], v[216:231]
    v_exp_f32 v106, v106
    v_exp_f32 v107, v107
    v_exp_f32 v108, v108
    v_exp_f32 v109, v109
    s_waitcnt vmcnt(6)
    v_mfma_f32_32x32x16_bf16 v[88:103], v[28:31], v[8:11], v[120:135]
    global_load_dwordx4 v[24:27], v1, s[24:25] offset:-3072 sc1
    v_exp_f32 v110, v110
    v_exp_f32 v111, v111
    v_cvt_pk_bf16_f32 v80, v104, v105
    v_cvt_pk_bf16_f32 v81, v106, v107
    v_cvt_pk_bf16_f32 v82, v108, v109
    v_cvt_pk_bf16_f32 v83, v110, v111
    v_exp_f32 v112, v112
    v_exp_f32 v113, v113
    v_mfma_f32_32x32x16_bf16 v[232:247], v[40:43], v[80:83], v[232:247]
    v_exp_f32 v114, v114
    v_exp_f32 v115, v115
    v_exp_f32 v116, v116
    v_exp_f32 v117, v117
    v_exp_f32 v118, v118
    v_exp_f32 v119, v119
    v_cvt_pk_bf16_f32 v84, v112, v113
    v_cvt_pk_bf16_f32 v85, v114, v115
    v_cvt_pk_bf16_f32 v86, v116, v117
    v_cvt_pk_bf16_f32 v87, v118, v119
    v_exp_f32 v88, v88
    v_exp_f32 v89, v89
    v_mfma_f32_32x32x16_bf16 v[232:247], v[44:47], v[84:87], v[232:247]
    s_mov_b64 exec, s[40:41]
    global_load_dwordx4 v[40:43], v1, s[24:25] offset:-2048 sc1
    global_load_dwordx4 v[44:47], v1, s[24:25] offset:-1792 sc1
    s_mov_b64 exec, -1
    v_exp_f32 v90, v90
    v_exp_f32 v91, v91
    v_exp_f32 v92, v92
    v_exp_f32 v93, v93
    v_mfma_f32_32x32x16_bf16 v[104:119], v[28:31], v[12:15], v[136:151]
    v_exp_f32 v94, v94
    v_exp_f32 v95, v95
    v_cvt_pk_bf16_f32 v72, v88, v89
    v_cvt_pk_bf16_f32 v73, v90, v91
    v_cvt_pk_bf16_f32 v74, v92, v93
    v_cvt_pk_bf16_f32 v75, v94, v95
    v_exp_f32 v96, v96
    v_exp_f32 v97, v97
    v_mfma_f32_32x32x16_bf16 v[184:199], v[48:51], v[72:75], v[184:199]
    v_exp_f32 v98, v98
    v_exp_f32 v99, v99
    v_exp_f32 v100, v100
    v_exp_f32 v101, v101
    v_exp_f32 v102, v102
    v_exp_f32 v103, v103
    v_cvt_pk_bf16_f32 v76, v96, v97
    v_cvt_pk_bf16_f32 v77, v98, v99
    v_cvt_pk_bf16_f32 v78, v100, v101
    v_cvt_pk_bf16_f32 v79, v102, v103
    v_exp_f32 v104, v104
    v_exp_f32 v105, v105
    v_mfma_f32_32x32x16_bf16 v[184:199], v[52:55], v[76:79], v[184:199]
    v_exp_f32 v106, v106
    v_exp_f32 v107, v107
    v_exp_f32 v108, v108
    v_exp_f32 v109, v109
    v_mfma_f32_32x32x16_bf16 v[88:103], v[28:31], v[16:19], v[152:167]
    v_exp_f32 v110, v110
    v_exp_f32 v111, v111
    v_cvt_pk_bf16_f32 v80, v104, v105
    v_cvt_pk_bf16_f32 v81, v106, v107
    v_cvt_pk_bf16_f32 v82, v108, v109
    v_cvt_pk_bf16_f32 v83, v110, v111
    v_exp_f32 v112, v112
    v_exp_f32 v113, v113
    v_mfma_f32_32x32x16_bf16 v[200:215], v[48:51], v[80:83], v[200:215]
    v_exp_f32 v114, v114
    v_exp_f32 v115, v115
    v_exp_f32 v116, v116
    v_exp_f32 v117, v117
    v_exp_f32 v118, v118
    v_exp_f32 v119, v119
    v_cvt_pk_bf16_f32 v84, v112, v113
    v_cvt_pk_bf16_f32 v85, v114, v115
    v_cvt_pk_bf16_f32 v86, v116, v117
    v_cvt_pk_bf16_f32 v87, v118, v119
    v_max_f32 v2, v240, v192
    v_cmp_lt_f32 vcc, 1.0, v2
    s_cbranch_vccnz A_rareB
A_rareB_ret:
    v_exp_f32 v88, v88
    v_exp_f32 v89, v89
    v_mfma_f32_32x32x16_bf16 v[200:215], v[52:55], v[84:87], v[200:215]
    v_exp_f32 v90, v90
    v_exp_f32 v91, v91
    v_exp_f32 v92, v92
    v_exp_f32 v93, v93
    v_mfma_f32_32x32x16_bf16 v[104:119], v[28:31], v[20:23], v[168:183]
    v_exp_f32 v94, v94
    v_exp_f32 v95, v95
    v_cvt_pk_bf16_f32 v72, v88, v89
    v_cvt_pk_bf16_f32 v73, v90, v91
    v_cvt_pk_bf16_f32 v74, v92, v93
    v_cvt_pk_bf16_f32 v75, v94, v95
    v_exp_f32 v96, v96
    v_exp_f32 v97, v97
    v_mfma_f32_32x32x16_bf16 v[216:231], v[48:51], v[72:75], v[216:231]
    v_exp_f32 v98, v98
    v_exp_f32 v99, v99
    v_exp_f32 v100, v100
    v_exp_f32 v101, v101
    v_exp_f32 v102, v102
    v_exp_f32 v103, v103
    v_cvt_pk_bf16_f32 v76, v96, v97
    v_cvt_pk_bf16_f32 v77, v98, v99
    v_cvt_pk_bf16_f32 v78, v100, v101
    v_cvt_pk_bf16_f32 v79, v102, v103
    v_exp_f32 v104, v104
    v_exp_f32 v105, v105
    v_mfma_f32_32x32x16_bf16 v[216:231], v[52:55], v[76:79], v[216:231]
    v_exp_f32 v106, v106
    v_exp_f32 v107, v107
    v_exp_f32 v108, v108
    v_exp_f32 v109, v109
    s_waitcnt vmcnt(6)
    v_mfma_f32_32x32x16_bf16 v[88:103], v[32:35], v[8:11], v[120:135]
    global_load_dwordx4 v[28:31], v1, s[24:25] offset:-1024 sc1
    v_exp_f32 v110, v110
    v_exp_f32 v111, v111
    v_cvt_pk_bf16_f32 v80, v104, v105
    v_cvt_pk_bf16_f32 v81, v106, v107
    v_cvt_pk_bf16_f32 v82, v108, v109
    v_cvt_pk_bf16_f32 v83, v110, v111
    v_exp_f32 v112, v112
    v_exp_f32 v113, v113
    v_mfma_f32_32x32x16_bf16 v[232:247], v[48:51], v[80:83], v[232:247]
    v_exp_f32 v114, v114
    v_exp_f32 v115, v115
    v_exp_f32 v116, v116
    v_exp_f32 v117, v117
    v_exp_f32 v118, v118
    v_exp_f32 v119, v119
    v_cvt_pk_bf16_f32 v84, v112, v113
    v_cvt_pk_bf16_f32 v85, v114, v115
    v_cvt_pk_bf16_f32 v86, v116, v117
    v_cvt_pk_bf16_f32 v87, v118, v119
    v_exp_f32 v88, v88
    v_exp_f32 v89, v89
    v_mfma_f32_32x32x16_bf16 v[232:247], v[52:55], v[84:87], v[232:247]
    s_mov_b64 exec, s[40:41]
    global_load_dwordx4 v[48:51], v1, s[24:25] offset:0 sc1
    global_load_dwordx4 v[52:55], v1, s[24:25] offset:256 sc1
    s_mov_b64 exec, -1
    v_exp_f32 v90, v90
    v_exp_f32 v91, v91
    v_exp_f32 v92, v92
    v_exp_f32 v93, v93
    v_mfma_f32_32x32x16_bf16 v[104:119], v[32:35], v[12:15], v[136:151]
    v_exp_f32 v94, v94
    v_exp_f32 v95, v95
    v_cvt_pk_bf16_f32 v72, v88, v89
    v_cvt_pk_bf16_f32 v73, v90, v91
    v_cvt_pk_bf16_f32 v74, v92, v93
    v_cvt_pk_bf16_f32 v75, v94, v95
    v_exp_f32 v96, v96
    v_exp_f32 v97, v97
    v_mfma_f32_32x32x16_bf16 v[184:199], v[56:59], v[72:75], v[184:199]
    v_exp_f32 v98, v98
    v_exp_f32 v99, v99
    v_exp_f32 v100, v100
    v_exp_f32 v101, v101
    v_exp_f32 v102, v102
    v_exp_f32 v103, v103
    v_cvt_pk_bf16_f32 v76, v96, v97
    v_cvt_pk_bf16_f32 v77, v98, v99
    v_cvt_pk_bf16_f32 v78, v100, v101
    v_cvt_pk_bf16_f32 v79, v102, v103
    v_exp_f32 v104, v104
    v_exp_f32 v105, v105
    v_mfma_f32_32x32x16_bf16 v[184:199], v[60:63], v[76:79], v[184:199]
    v_exp_f32 v106, v106
    v_exp_f32 v107, v107
    v_exp_f32 v108, v108
    v_exp_f32 v109, v109
    v_mfma_f32_32x32x16_bf16 v[88:103], v[32:35], v[16:19], v[152:167]
    v_exp_f32 v110, v110
    v_exp_f32 v111, v111
    v_cvt_pk_bf16_f32 v80, v104, v105
    v_cvt_pk_bf16_f32 v81, v106, v107
    v_cvt_pk_bf16_f32 v82, v108, v109
    v_cvt_pk_bf16_f32 v83, v110, v111
    v_exp_f32 v112, v112
    v_exp_f32 v113, v113
    v_mfma_f32_32x32x16_bf16 v[200:215], v[56:59], v[80:83], v[200:215]
    v_exp_f32 v114, v114
    v_exp_f32 v115, v115
    v_exp_f32 v116, v116
    v_exp_f32 v117, v117
    v_exp_f32 v118, v118
    v_exp_f32 v119, v119
    v_cvt_pk_bf16_f32 v84, v112, v113
    v_cvt_pk_bf16_f32 v85, v114, v115
    v_cvt_pk_bf16_f32 v86, v116, v117
    v_cvt_pk_bf16_f32 v87, v118, v119
    v_exp_f32 v88, v88
    v_exp_f32 v89, v89
    v_mfma_f32_32x32x16_bf16 v[200:215], v[60:63], v[84:87], v[200:215]
    v_exp_f32 v90, v90
    v_exp_f32 v91, v91
    v_exp_f32 v92, v92
    v_exp_f32 v93, v93
    v_mfma_f32_32x32x16_bf16 v[104:119], v[32:35], v[20:23], v[168:183]
    v_exp_f32 v94, v94
    v_exp_f32 v95, v95
    v_cvt_pk_bf16_f32 v72, v88, v89
    v_cvt_pk_bf16_f32 v73, v90, v91
    v_cvt_pk_bf16_f32 v74, v92, v93
    v_cvt_pk_bf16_f32 v75, v94, v95
    v_exp_f32 v96, v96
    v_exp_f32 v97, v97
    v_mfma_f32_32x32x16_bf16 v[216:231], v[56:59], v[72:75], v[216:231]
    v_exp_f32 v98, v98
    v_exp_f32 v99, v99
    v_exp_f32 v100, v100
    v_exp_f32 v101, v101
    v_exp_f32 v102, v102
    v_exp_f32 v103, v103
    v_cvt_pk_bf16_f32 v76, v96, v97
    v_cvt_pk_bf16_f32 v77, v98, v99
    v_cvt_pk_bf16_f32 v78, v100, v101
    v_cvt_pk_bf16_f32 v79, v102, v103
    v_exp_f32 v104, v104
    v_exp_f32 v105, v105
    v_mfma_f32_32x32x16_bf16 v[216:231], v[60:63], v[76:79], v[216:231]
    v_exp_f32 v106, v106
    v_exp_f32 v107, v107
    v_exp_f32 v108, v108
    v_exp_f32 v109, v109
    s_waitcnt vmcnt(6)
    v_mfma_f32_32x32x16_bf16 v[88:103], v[36:39], v[8:11], v[120:135]
    global_load_dwordx4 v[32:35], v1, s[24:25] offset:1024 sc1
    v_exp_f32 v110, v110
    v_exp_f32 v111, v111
    v_cvt_pk_bf16_f32 v80, v104, v105
    v_cvt_pk_bf16_f32 v81, v106, v107
    v_cvt_pk_bf16_f32 v82, v108, v109
    v_cvt_pk_bf16_f32 v83, v110, v111
    v_exp_f32 v112, v112
    v_exp_f32 v113, v113
    v_mfma_f32_32x32x16_bf16 v[232:247], v[56:59], v[80:83], v[232:247]
    v_exp_f32 v114, v114
    v_exp_f32 v115, v115
    v_exp_f32 v116, v116
    v_exp_f32 v117, v117
    v_exp_f32 v118, v118
    v_exp_f32 v119, v119
    v_cvt_pk_bf16_f32 v84, v112, v113
    v_cvt_pk_bf16_f32 v85, v114, v115
    v_cvt_pk_bf16_f32 v86, v116, v117
    v_cvt_pk_bf16_f32 v87, v118, v119
    v_exp_f32 v88, v88
    v_exp_f32 v89, v89
    v_mfma_f32_32x32x16_bf16 v[232:247], v[60:63], v[84:87], v[232:247]
    s_mov_b64 exec, s[40:41]
    global_load_dwordx4 v[56:59], v1, s[24:25] offset:2048 sc1
    global_load_dwordx4 v[60:63], v1, s[24:25] offset:2304 sc1
    s_mov_b64 exec, -1
    v_exp_f32 v90, v90
    v_exp_f32 v91, v91
    v_exp_f32 v92, v92
    v_exp_f32 v93, v93
    v_mfma_f32_32x32x16_bf16 v[104:119], v[36:39], v[12:15], v[136:151]
    v_exp_f32 v94, v94
    v_exp_f32 v95, v95
    v_cvt_pk_bf16_f32 v72, v88, v89
    v_cvt_pk_bf16_f32 v73, v90, v91
    v_cvt_pk_bf16_f32 v74, v92, v93
    v_cvt_pk_bf16_f32 v75, v94, v95
    v_exp_f32 v96, v96
    v_exp_f32 v97, v97
    v_mfma_f32_32x32x16_bf16 v[184:199], v[64:67], v[72:75], v[184:199]
    v_exp_f32 v98, v98
    v_exp_f32 v99, v99
    v_exp_f32 v100, v100
    v_exp_f32 v101, v101
    v_exp_f32 v102, v102
    v_exp_f32 v103, v103
    v_cvt_pk_bf16_f32 v76, v96, v97
    v_cvt_pk_bf16_f32 v77, v98, v99
    v_cvt_pk_bf16_f32 v78, v100, v101
    v_cvt_pk_bf16_f32 v79, v102, v103
    v_exp_f32 v104, v104
    v_exp_f32 v105, v105
    v_mfma_f32_32x32x16_bf16 v[184:199], v[68:71], v[76:79], v[184:199]
    v_exp_f32 v106, v106
    v_exp_f32 v107, v107
    v_exp_f32 v108, v108
    v_exp_f32 v109, v109
    v_mfma_f32_32x32x16_bf16 v[88:103], v[36:39], v[16:19], v[152:167]
    v_exp_f32 v110, v110
    v_exp_f32 v111, v111
    v_cvt_pk_bf16_f32 v80, v104, v105
    v_cvt_pk_bf16_f32 v81, v106, v107
    v_cvt_pk_bf16_f32 v82, v108, v109
    v_cvt_pk_bf16_f32 v83, v110, v111
    v_exp_f32 v112, v112
    v_exp_f32 v113, v113
    v_mfma_f32_32x32x16_bf16 v[200:215], v[64:67], v[80:83], v[200:215]
    v_exp_f32 v114, v114
    v_exp_f32 v115, v115
    v_exp_f32 v116, v116
    v_exp_f32 v117, v117
    v_exp_f32 v118, v118
    v_exp_f32 v119, v119
    v_cvt_pk_bf16_f32 v84, v112, v113
    v_cvt_pk_bf16_f32 v85, v114, v115
    v_cvt_pk_bf16_f32 v86, v116, v117
    v_cvt_pk_bf16_f32 v87, v118, v119
    v_exp_f32 v88, v88
    v_exp_f32 v89, v89
    v_mfma_f32_32x32x16_bf16 v[200:215], v[68:71], v[84:87], v[200:215]
    v_exp_f32 v90, v90
    v_exp_f32 v91, v91
    v_exp_f32 v92, v92
    v_exp_f32 v93, v93
    v_mfma_f32_32x32x16_bf16 v[104:119], v[36:39], v[20:23], v[168:183]
    v_exp_f32 v94, v94
    v_exp_f32 v95, v95
    v_cvt_pk_bf16_f32 v72, v88, v89
    v_cvt_pk_bf16_f32 v73, v90, v91
    v_cvt_pk_bf16_f32 v74, v92, v93
    v_cvt_pk_bf16_f32 v75, v94, v95
    v_exp_f32 v96, v96
    v_exp_f32 v97, v97
    v_mfma_f32_32x32x16_bf16 v[216:231], v[64:67], v[72:75], v[216:231]
    v_exp_f32 v98, v98
    v_exp_f32 v99, v99
    v_exp_f32 v100, v100
    v_exp_f32 v101, v101
    v_exp_f32 v102, v102
    v_exp_f32 v103, v103
    v_cvt_pk_bf16_f32 v76, v96, v97
    v_cvt_pk_bf16_f32 v77, v98, v99
    v_cvt_pk_bf16_f32 v78, v100, v101
    v_cvt_pk_bf16_f32 v79, v102, v103
    v_exp_f32 v104, v104
    v_exp_f32 v105, v105
    v_mfma_f32_32x32x16_bf16 v[216:231], v[68:71], v[76:79], v[216:231]
    v_exp_f32 v106, v106
    v_exp_f32 v107, v107
    v_exp_f32 v108, v108
    v_exp_f32 v109, v109
    s_waitcnt vmcnt(6)
    v_mfma_f32_32x32x16_bf16 v[88:103], v[24:27], v[8:11], v[120:135]
    global_load_dwordx4 v[36:39], v1, s[24:25] offset:3072 sc1
    v_exp_f32 v110, v110
    v_exp_f32 v111, v111
    v_cvt_pk_bf16_f32 v80, v104, v105
    v_cvt_pk_bf16_f32 v81, v106, v107
    v_cvt_pk_bf16_f32 v82, v108, v109
    v_cvt_pk_bf16_f32 v83, v110, v111
    v_exp_f32 v112, v112
    v_exp_f32 v113, v113
    v_mfma_f32_32x32x16_bf16 v[232:247], v[64:67], v[80:83], v[232:247]
    v_exp_f32 v114, v114
    v_exp_f32 v115, v115
    v_exp_f32 v116, v116
    v_exp_f32 v117, v117
    v_exp_f32 v118, v118
    v_exp_f32 v119, v119
    v_cvt_pk_bf16_f32 v84, v112, v113
    v_cvt_pk_bf16_f32 v85, v114, v115
    v_cvt_pk_bf16_f32 v86, v116, v117
    v_cvt_pk_bf16_f32 v87, v118, v119
    v_max_f32 v2, v208, v224
    v_cmp_lt_f32 vcc, 1.0, v2
    s_cbranch_vccnz A_rareA
A_rareA_ret:
    s_add_u32 s24, s24, 8192
    s_addc_u32 s25, s25, 0
    s_sub_u32 s17, s17, 1
    s_cmp_lg_u32 s17, 0
    s_cbranch_scc1 A_loop
    v_mfma_f32_32x32x16_bf16 v[232:247], v[68:71], v[84:87], v[232:247]
    v_mov_b32 v2, 0
    v_cmp_nle_f32 vcc, v192, v6
    v_fmac_f32 v2, 0, v184
    v_fmac_f32 v2, 0, v185
    v_fmac_f32 v2, 0, v186
    v_fmac_f32 v2, 0, v187
    v_fmac_f32 v2, 0, v188
    v_fmac_f32 v2, 0, v189
    v_fmac_f32 v2, 0, v190
    v_fmac_f32 v2, 0, v191
    s_or_b64 s[42:43], s[42:43], vcc
    v_cmp_nle_f32 vcc, v208, v6
    v_fmac_f32 v2, 0, v200
    v_fmac_f32 v2, 0, v201
    v_fmac_f32 v2, 0, v202
    v_fmac_f32 v2, 0, v203
    v_fmac_f32 v2, 0, v204
    v_fmac_f32 v2, 0, v205
    v_fmac_f32 v2, 0, v206
    v_fmac_f32 v2, 0, v207
    s_or_b64 s[42:43], s[42:43], vcc
    v_cmp_nle_f32 vcc, v224, v6
    v_fmac_f32 v2, 0, v216
    v_fmac_f32 v2, 0, v217
    v_fmac_f32 v2, 0, v218
    v_fmac_f32 v2, 0, v219
    v_fmac_f32 v2, 0, v220
    v_fmac_f32 v2, 0, v221
    v_fmac_f32 v2, 0, v222
    v_fmac_f32 v2, 0, v223
    s_or_b64 s[42:43], s[42:43], vcc
    s_nop 3
    v_cmp_nle_f32 vcc, v240, v6
    v_fmac_f32 v2, 0, v232
    v_fmac_f32 v2, 0, v233
    v_fmac_f32 v2, 0, v234
    v_fmac_f32 v2, 0, v235
    v_fmac_f32 v2, 0, v236
    v_fmac_f32 v2, 0, v237
    v_fmac_f32 v2, 0, v238
    v_fmac_f32 v2, 0, v239
    s_or_b64 s[42:43], s[42:43], vcc
    v_cmp_u_f32 vcc, v2, v2
    s_nop 0
    s_or_b64 s[42:43], s[42:43], vcc
    s_cbranch_scc0 A_epi
    s_cmp_eq_u32 s44, 0
    s_cbranch_scc1 A_fallback
A_epi:
    s_mul_i32 s26, s13, 4608
    s_add_u32 s26, s26, 131072
    v_add_u32 v4, s26, v1
    v_lshl_add_u32 v5, v0, 2, s26
    v_rcp_f32 v250, v224
    v_log_f32 v254, v224
    v_rcp_f32 v251, v240
    v_log_f32 v255, v240
    v_rcp_f32 v248, v192
    v_log_f32 v252, v192
    v_rcp_f32 v249, v208
    v_log_f32 v253, v208
    v_mul_f32 v216, v216, v250
    v_mul_f32 v217, v217, v250
    v_mul_f32 v218, v218, v250
    v_mul_f32 v219, v219, v250
    v_mul_f32 v220, v220, v250
    v_mul_f32 v221, v221, v250
    v_mul_f32 v222, v222, v250
    v_mul_f32 v223, v223, v250
    v_sub_f32 v254, v254, v152
    ds_write_b128 v4, v[216:219] offset:0
    ds_write_b128 v4, v[220:223] offset:1024
    ds_write_b32 v5, v254 offset:2048
    v_mul_f32 v232, v232, v251
    v_mul_f32 v233, v233, v251
    v_mul_f32 v234, v234, v251
    v_mul_f32 v235, v235, v251
    v_mul_f32 v236, v236, v251
    v_mul_f32 v237, v237, v251
    v_mul_f32 v238, v238, v251
    v_mul_f32 v239, v239, v251
    v_sub_f32 v255, v255, v168
    ds_write_b128 v4, v[232:235] offset:2304
    ds_write_b128 v4, v[236:239] offset:3328
    ds_write_b32 v5, v255 offset:4352
    s_lshl_b32 s27, s13, 2
    s_add_u32 s27, s27, 149512
    v_mov_b32 v7, s27
    v_mov_b32 v3, 1
    ds_write_b32 v7, v3
    v_xor_b32 v7, 4, v7
    s_xor_b32 s27, s13, 1
    s_mul_i32 s27, s27, 4608
    s_add_u32 s27, s27, 131072
    v_add_u32 v4, s27, v1
    v_lshl_add_u32 v5, v0, 2, s27
    v_mul_f32 v184, v184, v248
    v_mul_f32 v185, v185, v248
    v_mul_f32 v186, v186, v248
    v_mul_f32 v187, v187, v248
    v_mul_f32 v188, v188, v248
    v_mul_f32 v189, v189, v248
    v_mul_f32 v190, v190, v248
    v_mul_f32 v191, v191, v248
    v_sub_f32 v252, v252, v120
    v_mul_f32 v200, v200, v249
    v_mul_f32 v201, v201, v249
    v_mul_f32 v202, v202, v249
    v_mul_f32 v203, v203, v249
    v_mul_f32 v204, v204, v249
    v_mul_f32 v205, v205, v249
    v_mul_f32 v206, v206, v249
    v_mul_f32 v207, v207, v249
    v_sub_f32 v253, v253, v136
    s_lshl_b32 s26, s16, 1
    s_add_u32 s26, s26, s15
    s_mul_i32 s26, s26, 88
    s_add_u32 s26, s26, s14
    s_lshl_b32 s26, s26, 10
    s_add_u32 s26, s26, 20971520
    s_add_u32 s24, s4, s26
    s_addc_u32 s25, s5, 0
    s_add_u32 s22, s24, 90112
    s_addc_u32 s23, s25, 0
A_w:
    ds_read_b32 v3, v7
    s_waitcnt lgkmcnt(0)
    v_readfirstlane_b32 s26, v3
    s_nop 0
    s_cmp_ge_u32 s26, 1
    s_cbranch_scc1 A_w_d
    s_sleep 1
    s_sub_u32 s98, s98, 1
    s_cmp_gt_i32 s98, 0
    s_cbranch_scc1 A_w
A_w_d:
    ds_read_b32 v128, v5 offset:2048
    ds_read_b128 v[120:123], v4 offset:0
    ds_read_b128 v[124:127], v4 offset:1024
    ds_read_b32 v140, v5 offset:4352
    ds_read_b128 v[132:135], v4 offset:2304
    ds_read_b128 v[136:139], v4 offset:3328
    s_waitcnt lgkmcnt(5)
    v_sub_f32 v129, v128, v252
    v_exp_f32 v129, v129
    s_waitcnt lgkmcnt(3)
    v_sub_f32 v184, v184, v120
    v_sub_f32 v185, v185, v121
    v_sub_f32 v186, v186, v122
    v_sub_f32 v187, v187, v123
    v_sub_f32 v188, v188, v124
    v_sub_f32 v189, v189, v125
    v_sub_f32 v190, v190, v126
    v_sub_f32 v191, v191, v127
    v_add_f32 v129, 1.0, v129
    v_rcp_f32 v129, v129
    s_nop 0
    v_fmac_f32 v120, v129, v184
    v_fmac_f32 v121, v129, v185
    v_fmac_f32 v122, v129, v186
    v_fmac_f32 v123, v129, v187
    v_fmac_f32 v124, v129, v188
    v_fmac_f32 v125, v129, v189
    v_fmac_f32 v126, v129, v190
    v_fmac_f32 v127, v129, v191
    v_cvt_pk_bf16_f32 v196, v120, v121
    v_cvt_pk_bf16_f32 v197, v122, v123
    v_cvt_pk_bf16_f32 v198, v124, v125
    v_cvt_pk_bf16_f32 v199, v126, v127
    global_store_dwordx4 v1, v[196:199], s[24:25] sc1
    s_waitcnt lgkmcnt(2)
    v_sub_f32 v141, v140, v253
    v_exp_f32 v141, v141
    s_waitcnt lgkmcnt(0)
    v_sub_f32 v200, v200, v132
    v_sub_f32 v201, v201, v133
    v_sub_f32 v202, v202, v134
    v_sub_f32 v203, v203, v135
    v_sub_f32 v204, v204, v136
    v_sub_f32 v205, v205, v137
    v_sub_f32 v206, v206, v138
    v_sub_f32 v207, v207, v139
    v_add_f32 v141, 1.0, v141
    v_rcp_f32 v141, v141
    s_nop 0
    v_fmac_f32 v132, v141, v200
    v_fmac_f32 v133, v141, v201
    v_fmac_f32 v134, v141, v202
    v_fmac_f32 v135, v141, v203
    v_fmac_f32 v136, v141, v204
    v_fmac_f32 v137, v141, v205
    v_fmac_f32 v138, v141, v206
    v_fmac_f32 v139, v141, v207
    v_cvt_pk_bf16_f32 v212, v132, v133
    v_cvt_pk_bf16_f32 v213, v134, v135
    v_cvt_pk_bf16_f32 v214, v136, v137
    v_cvt_pk_bf16_f32 v215, v138, v139
    global_store_dwordx4 v1, v[212:215], s[22:23] sc1
    s_lshl_b32 s26, s62, 2
    s_add_u32 s26, s26, s13
    s_lshl_b32 s26, s26, 2
    s_lshr_b32 s27, s14, 3
    s_add_u32 s26, s26, s27
    s_lshl_b32 s26, s26, 5
    s_and_b32 s27, s14, 7
    s_add_u32 s26, s26, s27
    s_lshl_b32 s26, s26, 2
    s_add_u32 s26, s26, 29130752
    v_mov_b32 v2, s26
    v_mov_b32 v3, s60
    s_waitcnt vmcnt(0)
    s_mov_b64 exec, 1
    global_store_dword v2, v3, s[4:5] sc1
    s_mov_b64 exec, -1
    s_endpgm
A_rareA:
    v_cmp_nle_f32 vcc, v208, v6
    v_frexp_exp_i32_f32 v2, v208
    s_or_b64 s[42:43], s[42:43], vcc
    v_add_u32 v2, 100, v2
    v_max_i32 v2, 0, v2
    v_cvt_f32_i32 v3, v2
    v_sub_u32 v2, 0, v2
    v_ldexp_f32 v200, v200, v2
    v_ldexp_f32 v201, v201, v2
    v_ldexp_f32 v202, v202, v2
    v_ldexp_f32 v203, v203, v2
    v_ldexp_f32 v204, v204, v2
    v_ldexp_f32 v205, v205, v2
    v_ldexp_f32 v206, v206, v2
    v_ldexp_f32 v207, v207, v2
    v_ldexp_f32 v208, v208, v2
    v_sub_f32 v136, v136, v3
    v_sub_f32 v137, v137, v3
    v_sub_f32 v138, v138, v3
    v_sub_f32 v139, v139, v3
    v_sub_f32 v140, v140, v3
    v_sub_f32 v141, v141, v3
    v_sub_f32 v142, v142, v3
    v_sub_f32 v143, v143, v3
    v_sub_f32 v144, v144, v3
    v_sub_f32 v145, v145, v3
    v_sub_f32 v146, v146, v3
    v_sub_f32 v147, v147, v3
    v_sub_f32 v148, v148, v3
    v_sub_f32 v149, v149, v3
    v_sub_f32 v150, v150, v3
    v_sub_f32 v151, v151, v3
    v_cmp_nle_f32 vcc, v224, v6
    v_frexp_exp_i32_f32 v2, v224
    s_or_b64 s[42:43], s[42:43], vcc
    v_add_u32 v2, 100, v2
    v_max_i32 v2, 0, v2
    v_cvt_f32_i32 v3, v2
    v_sub_u32 v2, 0, v2
    v_ldexp_f32 v216, v216, v2
    v_ldexp_f32 v217, v217, v2
    v_ldexp_f32 v218, v218, v2
    v_ldexp_f32 v219, v219, v2
    v_ldexp_f32 v220, v220, v2
    v_ldexp_f32 v221, v221, v2
    v_ldexp_f32 v222, v222, v2
    v_ldexp_f32 v223, v223, v2
    v_ldexp_f32 v224, v224, v2
    v_sub_f32 v152, v152, v3
    v_sub_f32 v153, v153, v3
    v_sub_f32 v154, v154, v3
    v_sub_f32 v155, v155, v3
    v_sub_f32 v156, v156, v3
    v_sub_f32 v157, v157, v3
    v_sub_f32 v158, v158, v3
    v_sub_f32 v159, v159, v3
    v_sub_f32 v160, v160, v3
    v_sub_f32 v161, v161, v3
    v_sub_f32 v162, v162, v3
    v_sub_f32 v163, v163, v3
    v_sub_f32 v164, v164, v3
    v_sub_f32 v165, v165, v3
    v_sub_f32 v166, v166, v3
    v_sub_f32 v167, v167, v3
    s_nop 0
    s_branch A_rareA_ret
A_rareB:
    v_cmp_nle_f32 vcc, v240, v6
    v_frexp_exp_i32_f32 v2, v240
    s_or_b64 s[42:43], s[42:43], vcc
    v_add_u32 v2, 100, v2
    v_max_i32 v2, 0, v2
    v_cvt_f32_i32 v3, v2
    v_sub_u32 v2, 0, v2
    v_ldexp_f32 v232, v232, v2
    v_ldexp_f32 v233, v233, v2
    v_ldexp_f32 v234, v234, v2
    v_ldexp_f32 v235, v235, v2
    v_ldexp_f32 v236, v236, v2
    v_ldexp_f32 v237, v237, v2
    v_ldexp_f32 v238, v238, v2
    v_ldexp_f32 v239, v239, v2
    v_ldexp_f32 v240, v240, v2
    v_sub_f32 v168, v168, v3
    v_sub_f32 v169, v169, v3
    v_sub_f32 v170, v170, v3
    v_sub_f32 v171, v171, v3
    v_sub_f32 v172, v172, v3
    v_sub_f32 v173, v173, v3
    v_sub_f32 v174, v174, v3
    v_sub_f32 v175, v175, v3
    v_sub_f32 v176, v176, v3
    v_sub_f32 v177, v177, v3
    v_sub_f32 v178, v178, v3
    v_sub_f32 v179, v179, v3
    v_sub_f32 v180, v180, v3
    v_sub_f32 v181, v181, v3
    v_sub_f32 v182, v182, v3
    v_sub_f32 v183, v183, v3
    v_cmp_nle_f32 vcc, v192, v6
    v_frexp_exp_i32_f32 v2, v192
    s_or_b64 s[42:43], s[42:43], vcc
    v_add_u32 v2, 100, v2
    v_max_i32 v2, 0, v2
    v_cvt_f32_i32 v3, v2
    v_sub_u32 v2, 0, v2
    v_ldexp_f32 v184, v184, v2
    v_ldexp_f32 v185, v185, v2
    v_ldexp_f32 v186, v186, v2
    v_ldexp_f32 v187, v187, v2
    v_ldexp_f32 v188, v188, v2
    v_ldexp_f32 v189, v189, v2
    v_ldexp_f32 v190, v190, v2
    v_ldexp_f32 v191, v191, v2
    v_ldexp_f32 v192, v192, v2
    v_sub_f32 v120, v120, v3
    v_sub_f32 v121, v121, v3
    v_sub_f32 v122, v122, v3
    v_sub_f32 v123, v123, v3
    v_sub_f32 v124, v124, v3
    v_sub_f32 v125, v125, v3
    v_sub_f32 v126, v126, v3
    v_sub_f32 v127, v127, v3
    v_sub_f32 v128, v128, v3
    v_sub_f32 v129, v129, v3
    v_sub_f32 v130, v130, v3
    v_sub_f32 v131, v131, v3
    v_sub_f32 v132, v132, v3
    v_sub_f32 v133, v133, v3
    v_sub_f32 v134, v134, v3
    v_sub_f32 v135, v135, v3
    s_nop 0
    s_branch A_rareB_ret
A_fallback:
    s_mov_b32 s44, 1
    s_waitcnt vmcnt(0)
    v_mov_b32 v248, 0xff800000
    v_mov_b32 v249, 0xff800000
    v_mov_b32 v250, 0xff800000
    v_mov_b32 v251, 0xff800000
    s_mov_b64 s[24:25], s[20:21]
    s_mov_b32 s17, 32
A_fbl:
    global_load_dwordx4 v[24:27], v1, s[24:25] offset:-4096 sc1
    s_add_u32 s24, s24, 2048
    s_addc_u32 s25, s25, 0
    s_waitcnt vmcnt(0)
    v_mfma_f32_32x32x16_bf16 v[120:135], v[24:27], v[8:11], 0
    v_mfma_f32_32x32x16_bf16 v[136:151], v[24:27], v[12:15], 0
    v_mfma_f32_32x32x16_bf16 v[152:167], v[24:27], v[16:19], 0
    v_mfma_f32_32x32x16_bf16 v[168:183], v[24:27], v[20:23], 0
    s_nop 11
    v_max3_f32 v248, v248, v120, v121
    v_max3_f32 v248, v248, v122, v123
    v_max3_f32 v248, v248, v124, v125
    v_max3_f32 v248, v248, v126, v127
    v_max3_f32 v248, v248, v128, v129
    v_max3_f32 v248, v248, v130, v131
    v_max3_f32 v248, v248, v132, v133
    v_max3_f32 v248, v248, v134, v135
    v_max3_f32 v249, v249, v136, v137
    v_max3_f32 v249, v249, v138, v139
    v_max3_f32 v249, v249, v140, v141
    v_max3_f32 v249, v249, v142, v143
    v_max3_f32 v249, v249, v144, v145
    v_max3_f32 v249, v249, v146, v147
    v_max3_f32 v249, v249, v148, v149
    v_max3_f32 v249, v249, v150, v151
    v_max3_f32 v250, v250, v152, v153
    v_max3_f32 v250, v250, v154, v155
    v_max3_f32 v250, v250, v156, v157
    v_max3_f32 v250, v250, v158, v159
    v_max3_f32 v250, v250, v160, v161
    v_max3_f32 v250, v250, v162, v163
    v_max3_f32 v250, v250, v164, v165
    v_max3_f32 v250, v250, v166, v167
    v_max3_f32 v251, v251, v168, v169
    v_max3_f32 v251, v251, v170, v171
    v_max3_f32 v251, v251, v172, v173
    v_max3_f32 v251, v251, v174, v175
    v_max3_f32 v251, v251, v176, v177
    v_max3_f32 v251, v251, v178, v179
    v_max3_f32 v251, v251, v180, v181
    v_max3_f32 v251, v251, v182, v183
    s_sub_u32 s17, s17, 1
    s_cmp_lg_u32 s17, 0
    s_cbranch_scc1 A_fbl
    s_branch A_restart
P2_gemm:
    s_load_dwordx2 s[6:7], s[0:1], 40
    s_load_dwordx2 s[28:29], s[0:1], 48
    s_load_dwordx2 s[34:35], s[0:1], 16
    s_load_dwordx2 s[36:37], s[0:1], 56
    s_sub_u32 s13, s13, 4
    v_mov_b32 v9, s66
    v_mov_b32 v10, s60
    s_waitcnt vmcnt(0)
    s_barrier
    s_cmp_eq_u32 s13, 0
    s_cbranch_scc0 G_npub
    s_mov_b64 exec, 1
    global_store_dword v9, v10, s[4:5] sc1
    s_mov_b64 exec, -1
G_npub:
    v_and_b32 v2, 0x70, v1
    v_add_u32 v2, 149504, v2
    v_mov_b64 v[4:5], 0
    v_mov_b64 v[6:7], 0
    ds_write_b128 v2, v[4:7]
    s_waitcnt lgkmcnt(0)
    s_barrier
    v_lshrrev_b32 v10, 3, v0
    v_lshlrev_b32 v3, 10, v10
    v_and_b32 v11, 7, v0
    v_and_b32 v10, 2, v10
    v_lshlrev_b32 v10, 1, v10
    v_xor_b32 v11, v11, v10
    v_lshl_add_u32 v3, v11, 4, v3
    s_lshl_b32 s23, s13, 14
    s_lshl_b32 s38, s62, 7
    s_lshl_b32 s18, s13, 17
    s_add_u32 s18, s18, s38
    s_lshl_b32 s39, s13, 2
    s_add_u32 s39, s39, 149536
    v_mov_b32 v6, s39
    v_mov_b32 v8, 1
    s_mul_i32 s58, s13, 224 * 1024
    s_add_u32 s58, s58, s38
    s_mov_b32 s57, s18
    s_cmp_ge_u32 s31, 28
    s_cbranch_scc0 G_go
    s_lshl_b32 s14, s30, 2
    s_add_u32 s14, s14, s31
    s_sub_u32 s14, s14, 28
    s_lshl_b32 s15, s14, 18
    s_lshl_b32 s16, s13, 10
    s_add_u32 s15, s15, s16
    v_lshlrev_b32 v2, 12, v0
    v_add_u32 v2, s15, v2
    s_lshl_b32 s14, s14, 2
    s_add_u32 s14, s14, s13
    s_lshl_b32 s15, s14, 13
    v_lshlrev_b32 v5, 7, v0
    v_add_u32 v5, s15, v5
    s_waitcnt lgkmcnt(0)
    s_mov_b32 s40, s34
    s_mov_b32 s41, s35
    s_mov_b32 s42, 524288
    s_mov_b32 s43, 0x20000
    s_mov_b32 s44, s36
    s_mov_b32 s45, s37
    s_mov_b32 s46, 917504
    s_mov_b32 s47, 0x20000
    global_load_dword v4, v2, s[6:7] offset:256
    s_waitcnt vmcnt(0)
    global_load_dword v4, v2, s[6:7] offset:384
    s_waitcnt vmcnt(0)
    global_load_dword v4, v2, s[6:7] offset:512
    s_waitcnt vmcnt(0)
    global_load_dword v4, v2, s[6:7] offset:640
    s_waitcnt vmcnt(0)
    global_load_dword v4, v2, s[6:7] offset:768
    s_waitcnt vmcnt(0)
    global_load_dword v4, v2, s[6:7] offset:896
    s_waitcnt vmcnt(0)
    s_cmp_lt_u32 s14, 64
    s_cbranch_scc0 G_i0
    global_load_dword v4, v5, s[34:35]
    s_waitcnt vmcnt(0)
G_i0:
    s_cmp_lt_u32 s14, 112
    s_cbranch_scc0 G_i1
    global_load_dword v4, v5, s[36:37]
    s_waitcnt vmcnt(0)
G_i1:
    s_add_u32 m0, s23, 0
    s_add_u32 s26, s58, 0
    buffer_load_dwordx4 v3, s[44:47], s26 offen lds
    s_add_u32 m0, s23, 1024
    s_add_u32 s26, s58, 8192
    buffer_load_dwordx4 v3, s[44:47], s26 offen lds
    s_add_u32 m0, s23, 2048
    s_add_u32 s26, s58, 16384
    buffer_load_dwordx4 v3, s[44:47], s26 offen lds
    s_add_u32 m0, s23, 3072
    s_add_u32 s26, s58, 24576
    buffer_load_dwordx4 v3, s[44:47], s26 offen lds
    s_add_u32 m0, s23, 4096
    s_add_u32 s26, s58, 32768
    buffer_load_dwordx4 v3, s[44:47], s26 offen lds
    s_add_u32 m0, s23, 5120
    s_add_u32 s26, s58, 40960
    buffer_load_dwordx4 v3, s[44:47], s26 offen lds
    s_add_u32 m0, s23, 6144
    s_add_u32 s26, s58, 49152
    buffer_load_dwordx4 v3, s[44:47], s26 offen lds
    s_add_u32 m0, s23, 7168
    s_add_u32 s26, s58, 57344
    buffer_load_dwordx4 v3, s[44:47], s26 offen lds
    s_add_u32 m0, s23, 8192
    s_add_u32 s26, s58, 65536
    buffer_load_dwordx4 v3, s[44:47], s26 offen lds
    s_add_u32 m0, s23, 9216
    s_add_u32 s26, s58, 73728
    buffer_load_dwordx4 v3, s[44:47], s26 offen lds
    s_add_u32 m0, s23, 10240
    s_add_u32 s26, s58, 81920
    buffer_load_dwordx4 v3, s[44:47], s26 offen lds
    s_add_u32 m0, s23, 11264
    s_add_u32 s26, s58, 90112
    buffer_load_dwordx4 v3, s[44:47], s26 offen lds
    s_add_u32 m0, s23, 12288
    s_add_u32 s26, s58, 98304
    buffer_load_dwordx4 v3, s[44:47], s26 offen lds
    s_add_u32 m0, s23, 13312
    s_add_u32 s26, s58, 106496
    buffer_load_dwordx4 v3, s[44:47], s26 offen lds
    s_add_u32 m0, s23, 14336
    s_add_u32 s26, s58, 114688
    buffer_load_dwordx4 v3, s[44:47], s26 offen lds
    s_add_u32 m0, s23, 15360
    s_add_u32 s26, s58, 122880
    buffer_load_dwordx4 v3, s[44:47], s26 offen lds
    s_add_u32 s22, s23, 65536
    v_lshrrev_b32 v9, 5, v0
    v_lshlrev_b32 v24, 9, v9
    v_bfe_u32 v9, v0, 2, 2
    v_lshl_add_u32 v24, v9, 7, v24
    v_lshrrev_b32 v9, 1, v9
    s_and_b32 s26, s13, 1
    v_xor_b32 v9, s26, v9
    v_lshl_add_u32 v24, v9, 6, v24
    v_bfe_u32 v9, v0, 4, 1
    v_lshl_add_u32 v24, v9, 5, v24
    v_and_b32 v9, 3, v0
    v_lshl_add_u32 v24, v9, 3, v24
    v_add_u32 v24, s22, v24
    v_xor_b32 v25, 64, v24
    v_subrev_u32 v14, 65536, v24
    v_subrev_u32 v15, 65536, v25
    s_mov_b32 s21, 1
    s_waitcnt vmcnt(0)
    s_branch G_stage
    s_add_u32 m0, s23, 0
    s_add_u32 s26, s18, 0
    buffer_load_dwordx4 v3, s[40:43], s26 offen lds
    s_add_u32 m0, s23, 1024
    s_add_u32 s26, s18, 8192
    buffer_load_dwordx4 v3, s[40:43], s26 offen lds
    s_add_u32 m0, s23, 2048
    s_add_u32 s26, s18, 16384
    buffer_load_dwordx4 v3, s[40:43], s26 offen lds
    s_add_u32 m0, s23, 3072
    s_add_u32 s26, s18, 24576
    buffer_load_dwordx4 v3, s[40:43], s26 offen lds
    s_add_u32 m0, s23, 4096
    s_add_u32 s26, s18, 32768
    buffer_load_dwordx4 v3, s[40:43], s26 offen lds
    s_add_u32 m0, s23, 5120
    s_add_u32 s26, s18, 40960
    buffer_load_dwordx4 v3, s[40:43], s26 offen lds
    s_add_u32 m0, s23, 6144
    s_add_u32 s26, s18, 49152
    buffer_load_dwordx4 v3, s[40:43], s26 offen lds
    s_add_u32 m0, s23, 7168
    s_add_u32 s26, s18, 57344
    buffer_load_dwordx4 v3, s[40:43], s26 offen lds
    s_add_u32 m0, s23, 8192
    s_add_u32 s26, s18, 65536
    buffer_load_dwordx4 v3, s[40:43], s26 offen lds
    s_add_u32 m0, s23, 9216
    s_add_u32 s26, s18, 73728
    buffer_load_dwordx4 v3, s[40:43], s26 offen lds
    s_add_u32 m0, s23, 10240
    s_add_u32 s26, s18, 81920
    buffer_load_dwordx4 v3, s[40:43], s26 offen lds
    s_add_u32 m0, s23, 11264
    s_add_u32 s26, s18, 90112
    buffer_load_dwordx4 v3, s[40:43], s26 offen lds
    s_add_u32 m0, s23, 12288
    s_add_u32 s26, s18, 98304
    buffer_load_dwordx4 v3, s[40:43], s26 offen lds
    s_add_u32 m0, s23, 13312
    s_add_u32 s26, s18, 106496
    buffer_load_dwordx4 v3, s[40:43], s26 offen lds
    s_add_u32 m0, s23, 14336
    s_add_u32 s26, s18, 114688
    buffer_load_dwordx4 v3, s[40:43], s26 offen lds
    s_add_u32 m0, s23, 15360
    s_add_u32 s26, s18, 122880
    buffer_load_dwordx4 v3, s[40:43], s26 offen lds
    s_waitcnt vmcnt(0)
    ds_write_b32 v6, v8
    s_add_u32 s22, s23, 65536
    s_mul_i32 s19, s13, 224 * 1024
    s_add_u32 s19, s19, s38
    s_add_u32 m0, s22, 0
    s_add_u32 s26, s19, 0
    buffer_load_dwordx4 v3, s[44:47], s26 offen lds
    s_add_u32 m0, s22, 1024
    s_add_u32 s26, s19, 8192
    buffer_load_dwordx4 v3, s[44:47], s26 offen lds
    s_add_u32 m0, s22, 2048
    s_add_u32 s26, s19, 16384
    buffer_load_dwordx4 v3, s[44:47], s26 offen lds
    s_add_u32 m0, s22, 3072
    s_add_u32 s26, s19, 24576
    buffer_load_dwordx4 v3, s[44:47], s26 offen lds
    s_add_u32 m0, s22, 4096
    s_add_u32 s26, s19, 32768
    buffer_load_dwordx4 v3, s[44:47], s26 offen lds
    s_add_u32 m0, s22, 5120
    s_add_u32 s26, s19, 40960
    buffer_load_dwordx4 v3, s[44:47], s26 offen lds
    s_add_u32 m0, s22, 6144
    s_add_u32 s26, s19, 49152
    buffer_load_dwordx4 v3, s[44:47], s26 offen lds
    s_add_u32 m0, s22, 7168
    s_add_u32 s26, s19, 57344
    buffer_load_dwordx4 v3, s[44:47], s26 offen lds
    s_add_u32 m0, s22, 8192
    s_add_u32 s26, s19, 65536
    buffer_load_dwordx4 v3, s[44:47], s26 offen lds
    s_add_u32 m0, s22, 9216
    s_add_u32 s26, s19, 73728
    buffer_load_dwordx4 v3, s[44:47], s26 offen lds
    s_add_u32 m0, s22, 10240
    s_add_u32 s26, s19, 81920
    buffer_load_dwordx4 v3, s[44:47], s26 offen lds
    s_add_u32 m0, s22, 11264
    s_add_u32 s26, s19, 90112
    buffer_load_dwordx4 v3, s[44:47], s26 offen lds
    s_add_u32 m0, s22, 12288
    s_add_u32 s26, s19, 98304
    buffer_load_dwordx4 v3, s[44:47], s26 offen lds
    s_add_u32 m0, s22, 13312
    s_add_u32 s26, s19, 106496
    buffer_load_dwordx4 v3, s[44:47], s26 offen lds
    s_add_u32 m0, s22, 14336
    s_add_u32 s26, s19, 114688
    buffer_load_dwordx4 v3, s[44:47], s26 offen lds
    s_add_u32 m0, s22, 15360
    s_add_u32 s26, s19, 122880
    buffer_load_dwordx4 v3, s[44:47], s26 offen lds
    v_lshrrev_b32 v9, 5, v0
    v_lshlrev_b32 v24, 9, v9
    v_bfe_u32 v9, v0, 2, 2
    v_lshl_add_u32 v24, v9, 7, v24
    v_lshrrev_b32 v9, 1, v9
    s_and_b32 s26, s13, 1
    v_xor_b32 v9, s26, v9
    v_lshl_add_u32 v24, v9, 6, v24
    v_bfe_u32 v9, v0, 4, 1
    v_lshl_add_u32 v24, v9, 5, v24
    v_and_b32 v9, 3, v0
    v_lshl_add_u32 v24, v9, 3, v24
    v_add_u32 v24, s22, v24
    v_xor_b32 v25, 64, v24
    s_setprio 0
    s_branch G_stage
G_go:
    s_and_b32 s26, s31, 3
    s_lshr_b32 s15, s31, 2
    s_lshl_b32 s14, s30, 2
    s_add_u32 s14, s14, s26
    s_lshl_b32 s16, s15, 2
    s_add_u32 s16, s16, s13
    v_lshrrev_b32 v7, 3, v0
    v_lshlrev_b32 v2, 12, v7
    v_lshrrev_b32 v7, 1, v7
    v_and_b32 v9, 7, v0
    v_xor_b32 v7, v7, v9
    v_lshl_add_u32 v2, v7, 4, v2
    v_xor_b32 v4, 64, v2
    s_lshl_b32 s19, s14, 18
    s_lshl_b32 s26, s13, 10
    s_add_u32 s19, s19, s26
    s_add_u32 s22, s23, 65536
    v_and_b32 v5, 31, v0
    v_lshlrev_b32 v12, 7, v5
    v_bfe_u32 v7, v0, 1, 3
    v_lshrrev_b32 v9, 5, v0
    v_xor_b32 v7, v7, v9
    v_lshl_add_u32 v12, v7, 4, v12
    v_add_u32 v12, s22, v12
    v_xor_b32 v13, 32, v12
    v_xor_b32 v14, 64, v12
    v_xor_b32 v15, 96, v12
    v_lshlrev_b32 v11, 1, v5
    v_add_u32 v16, s22, v1
    s_xor_b32 s26, s22, 0x4000
    v_add_u32 v17, s26, v1
    s_xor_b32 s26, s22, 0xc000
    v_add_u32 v18, s26, v1
    s_lshl_b32 s26, s13, 2
    s_add_u32 s26, s26, 149568
    v_mov_b32 v19, s26
    v_xor_b32 v20, 4, v19
    v_xor_b32 v21, 8, v19
    v_mov_b32 v22, 2
    v_mov_b32 v7, 149504
    v_lshrrev_b32 v9, 5, v0
    v_lshlrev_b32 v24, 9, v9
    v_bfe_u32 v9, v0, 2, 2
    v_lshl_add_u32 v24, v9, 7, v24
    v_lshrrev_b32 v9, 1, v9
    s_and_b32 s26, s13, 1
    v_xor_b32 v9, s26, v9
    v_lshl_add_u32 v24, v9, 6, v24
    v_bfe_u32 v9, v0, 4, 1
    v_lshl_add_u32 v24, v9, 5, v24
    v_and_b32 v9, 3, v0
    v_lshl_add_u32 v24, v9, 3, v24
    v_add_u32 v24, s22, v24
    v_xor_b32 v25, 64, v24
    v_mov_b64 v[28:29], 0
    v_mov_b64 v[30:31], 0
    s_lshr_b32 s26, s14, 1
    s_lshl_b32 s26, s26, 2
    s_add_u32 s26, s26, 29164544
    v_and_b32 v27, 7, v0
    v_lshl_add_u32 v27, v27, 7, s26
    s_xor_b32 s26, s13, 0
    s_lshl_b32 s27, s15, 2
    s_add_u32 s26, s26, s27
    s_lshl_b32 s26, s26, 2
    s_add_u32 s26, s26, s13
    s_lshl_b32 s26, s26, 15
    s_add_u32 s26, s26, 16781312
    s_add_u32 s48, s4, s26
    s_addc_u32 s49, s5, 0
    s_xor_b32 s26, s13, 1
    s_lshl_b32 s27, s15, 2
    s_add_u32 s26, s26, s27
    s_lshl_b32 s26, s26, 2
    s_add_u32 s26, s26, s13
    s_lshl_b32 s26, s26, 15
    s_add_u32 s26, s26, 16781312
    s_add_u32 s50, s4, s26
    s_addc_u32 s51, s5, 0
    s_xor_b32 s26, s13, 2
    s_lshl_b32 s27, s15, 2
    s_add_u32 s26, s26, s27
    s_lshl_b32 s26, s26, 2
    s_add_u32 s26, s26, s13
    s_lshl_b32 s26, s26, 15
    s_add_u32 s26, s26, 16781312
    s_add_u32 s52, s4, s26
    s_addc_u32 s53, s5, 0
    s_xor_b32 s26, s13, 3
    s_lshl_b32 s27, s15, 2
    s_add_u32 s26, s26, s27
    s_lshl_b32 s26, s26, 2
    s_add_u32 s26, s26, s13
    s_lshl_b32 s26, s26, 15
    s_add_u32 s26, s26, 16781312
    s_add_u32 s54, s4, s26
    s_addc_u32 s55, s5, 0
    s_waitcnt lgkmcnt(0)
    s_mov_b32 s8, s6
    s_mov_b32 s9, s7
    s_mov_b32 s10, 8388608
    s_mov_b32 s11, 0x20000
    s_mov_b32 s40, s34
    s_mov_b32 s41, s35
    s_mov_b32 s42, 524288
    s_mov_b32 s43, 0x20000
    s_mov_b32 s44, s36
    s_mov_b32 s45, s37
    s_mov_b32 s46, 917504
    s_mov_b32 s47, 0x20000
    s_add_u32 m0, s22, 0
    s_add_u32 s26, s19, 0
    buffer_load_dwordx4 v2, s[8:11], s26 offen lds
    s_add_u32 m0, s22, 1024
    s_add_u32 s26, s19, 32768
    buffer_load_dwordx4 v4, s[8:11], s26 offen lds
    s_add_u32 m0, s22, 2048
    s_add_u32 s26, s19, 65536
    buffer_load_dwordx4 v2, s[8:11], s26 offen lds
    s_add_u32 m0, s22, 3072
    s_add_u32 s26, s19, 98304
    buffer_load_dwordx4 v4, s[8:11], s26 offen lds
    s_add_u32 m0, s22, 4096
    s_add_u32 s26, s19, 131072
    buffer_load_dwordx4 v2, s[8:11], s26 offen lds
    s_add_u32 m0, s22, 5120
    s_add_u32 s26, s19, 163840
    buffer_load_dwordx4 v4, s[8:11], s26 offen lds
    s_add_u32 m0, s22, 6144
    s_add_u32 s26, s19, 196608
    buffer_load_dwordx4 v2, s[8:11], s26 offen lds
    s_add_u32 m0, s22, 7168
    s_add_u32 s26, s19, 229376
    buffer_load_dwordx4 v4, s[8:11], s26 offen lds
    s_add_u32 s19, s19, 128
    v_mfma_f32_32x32x16_bf16 v[128:143], v[28:31], v[28:31], 0
    v_mfma_f32_32x32x16_bf16 v[144:159], v[28:31], v[28:31], 0
    v_mfma_f32_32x32x16_bf16 v[160:175], v[28:31], v[28:31], 0
    v_mfma_f32_32x32x16_bf16 v[176:191], v[28:31], v[28:31], 0
    v_mfma_f32_32x32x16_bf16 v[192:207], v[28:31], v[28:31], 0
    v_mfma_f32_32x32x16_bf16 v[208:223], v[28:31], v[28:31], 0
    v_mfma_f32_32x32x16_bf16 v[224:239], v[28:31], v[28:31], 0
    v_mfma_f32_32x32x16_bf16 v[240:255], v[28:31], v[28:31], 0
    s_add_u32 m0, s22, 8192
    s_add_u32 s26, s19, 0
    buffer_load_dwordx4 v2, s[8:11], s26 offen lds
    s_add_u32 m0, s22, 9216
    s_add_u32 s26, s19, 32768
    buffer_load_dwordx4 v4, s[8:11], s26 offen lds
    s_add_u32 m0, s22, 10240
    s_add_u32 s26, s19, 65536
    buffer_load_dwordx4 v2, s[8:11], s26 offen lds
    s_add_u32 m0, s22, 11264
    s_add_u32 s26, s19, 98304
    buffer_load_dwordx4 v4, s[8:11], s26 offen lds
    s_add_u32 m0, s22, 12288
    s_add_u32 s26, s19, 131072
    buffer_load_dwordx4 v2, s[8:11], s26 offen lds
    s_add_u32 m0, s22, 13312
    s_add_u32 s26, s19, 163840
    buffer_load_dwordx4 v4, s[8:11], s26 offen lds
    s_add_u32 m0, s22, 14336
    s_add_u32 s26, s19, 196608
    buffer_load_dwordx4 v2, s[8:11], s26 offen lds
    s_add_u32 m0, s22, 15360
    s_add_u32 s26, s19, 229376
    buffer_load_dwordx4 v4, s[8:11], s26 offen lds
    s_add_u32 s19, s19, 128
    v_mov_b32 v10, 149588
    s_setprio 1
    s_cmp_eq_u32 s13, 0
    s_cbranch_scc1 G_pz0
G_lw:
    ds_read_b32 v9, v10
    s_waitcnt lgkmcnt(0)
    v_readfirstlane_b32 s27, v9
    s_nop 0
    s_cmp_ge_u32 s27, 1
    s_cbranch_scc1 G_lw_d
    s_sleep 8
    s_sub_u32 s98, s98, 1
    s_cmp_gt_i32 s98, 0
    s_cbranch_scc1 G_lw
G_lw_d:
    s_branch G_pzd
G_pz0:
    v_lshrrev_b32 v9, 4, v0
    s_cmp_eq_u32 s15, 6
    s_cselect_b32 s27, 1, 0
    v_and_b32 v9, s27, v9
    v_lshlrev_b32 v9, 7, v9
    v_and_b32 v23, 15, v0
    v_lshl_add_u32 v9, v23, 2, v9
    s_lshl_b32 s26, s15, 7
    s_add_u32 s26, s26, 29164544
    v_add_u32 v9, s26, v9
    s_mov_b64 exec, 4294967295
G_pz:
    global_load_dword v23, v9, s[4:5] sc1
    s_waitcnt vmcnt(0)
    v_cmp_ne_u32 vcc, s60, v23
    s_cbranch_vccz G_pz_d
    s_sleep 8
    s_sub_u32 s98, s98, 1
    s_cmp_gt_i32 s98, 0
    s_cbranch_scc1 G_pz
G_pz_d:
    s_mov_b64 exec, -1
    ds_write_b32 v10, v8
G_pzd:
    s_setprio 0
    global_load_dwordx4 v[64:67], v1, s[48:49] offset:-4096 sc1
    global_load_dwordx4 v[68:71], v1, s[50:51] offset:-4096 sc1
    global_load_dwordx4 v[72:75], v1, s[52:53] offset:-4096 sc1
    global_load_dwordx4 v[76:79], v1, s[54:55] offset:-4096 sc1
    global_load_dwordx4 v[80:83], v1, s[48:49] offset:-3072 sc1
    global_load_dwordx4 v[84:87], v1, s[50:51] offset:-3072 sc1
    global_load_dwordx4 v[88:91], v1, s[52:53] offset:-3072 sc1
    global_load_dwordx4 v[92:95], v1, s[54:55] offset:-3072 sc1
    global_load_dwordx4 v[96:99], v1, s[48:49] offset:-2048 sc1
    global_load_dwordx4 v[100:103], v1, s[50:51] offset:-2048 sc1
    global_load_dwordx4 v[104:107], v1, s[52:53] offset:-2048 sc1
    global_load_dwordx4 v[108:111], v1, s[54:55] offset:-2048 sc1
    global_load_dwordx4 v[112:115], v1, s[48:49] offset:-1024 sc1
    global_load_dwordx4 v[116:119], v1, s[50:51] offset:-1024 sc1
    global_load_dwordx4 v[120:123], v1, s[52:53] offset:-1024 sc1
    global_load_dwordx4 v[124:127], v1, s[54:55] offset:-1024 sc1
    s_mov_b32 s17, 4
    s_waitcnt vmcnt(0)
    s_setprio 0
G_loop:
    ds_read_b128 v[32:35], v12 offset:0
    ds_read_b128 v[36:39], v13 offset:0
    ds_read_b128 v[40:43], v14 offset:0
    ds_read_b128 v[44:47], v15 offset:0
    ds_read_b128 v[48:51], v12 offset:4096
    ds_read_b128 v[52:55], v13 offset:4096
    ds_read_b128 v[56:59], v14 offset:4096
    ds_read_b128 v[60:63], v15 offset:4096
    s_waitcnt lgkmcnt(0)
    s_waitcnt vmcnt(22)
    v_mfma_f32_32x32x16_bf16 v[128:143], v[64:67], v[32:35], v[128:143]
    v_mfma_f32_32x32x16_bf16 v[144:159], v[64:67], v[48:51], v[144:159]
    s_add_u32 m0, s22, 0
    s_add_u32 s26, s19, 0
    buffer_load_dwordx4 v2, s[8:11], s26 offen lds
    global_load_dwordx4 v[64:67], v1, s[48:49] offset:0 sc1
    s_waitcnt vmcnt(22)
    v_mfma_f32_32x32x16_bf16 v[160:175], v[68:71], v[32:35], v[160:175]
    v_mfma_f32_32x32x16_bf16 v[176:191], v[68:71], v[48:51], v[176:191]
    s_add_u32 m0, s22, 1024
    s_add_u32 s26, s19, 32768
    buffer_load_dwordx4 v4, s[8:11], s26 offen lds
    global_load_dwordx4 v[68:71], v1, s[50:51] offset:0 sc1
    s_waitcnt vmcnt(22)
    v_mfma_f32_32x32x16_bf16 v[192:207], v[72:75], v[32:35], v[192:207]
    v_mfma_f32_32x32x16_bf16 v[208:223], v[72:75], v[48:51], v[208:223]
    s_add_u32 m0, s22, 2048
    s_add_u32 s26, s19, 65536
    buffer_load_dwordx4 v2, s[8:11], s26 offen lds
    global_load_dwordx4 v[72:75], v1, s[52:53] offset:0 sc1
    s_waitcnt vmcnt(22)
    v_mfma_f32_32x32x16_bf16 v[224:239], v[76:79], v[32:35], v[224:239]
    v_mfma_f32_32x32x16_bf16 v[240:255], v[76:79], v[48:51], v[240:255]
    s_add_u32 m0, s22, 3072
    s_add_u32 s26, s19, 98304
    buffer_load_dwordx4 v4, s[8:11], s26 offen lds
    global_load_dwordx4 v[76:79], v1, s[54:55] offset:0 sc1
    s_waitcnt vmcnt(22)
    v_mfma_f32_32x32x16_bf16 v[128:143], v[80:83], v[36:39], v[128:143]
    v_mfma_f32_32x32x16_bf16 v[144:159], v[80:83], v[52:55], v[144:159]
    s_add_u32 m0, s22, 4096
    s_add_u32 s26, s19, 131072
    buffer_load_dwordx4 v2, s[8:11], s26 offen lds
    global_load_dwordx4 v[80:83], v1, s[48:49] offset:1024 sc1
    s_waitcnt vmcnt(22)
    v_mfma_f32_32x32x16_bf16 v[160:175], v[84:87], v[36:39], v[160:175]
    v_mfma_f32_32x32x16_bf16 v[176:191], v[84:87], v[52:55], v[176:191]
    s_add_u32 m0, s22, 5120
    s_add_u32 s26, s19, 163840
    buffer_load_dwordx4 v4, s[8:11], s26 offen lds
    global_load_dwordx4 v[84:87], v1, s[50:51] offset:1024 sc1
    s_waitcnt vmcnt(22)
    v_mfma_f32_32x32x16_bf16 v[192:207], v[88:91], v[36:39], v[192:207]
    v_mfma_f32_32x32x16_bf16 v[208:223], v[88:91], v[52:55], v[208:223]
    s_add_u32 m0, s22, 6144
    s_add_u32 s26, s19, 196608
    buffer_load_dwordx4 v2, s[8:11], s26 offen lds
    global_load_dwordx4 v[88:91], v1, s[52:53] offset:1024 sc1
    s_waitcnt vmcnt(22)
    v_mfma_f32_32x32x16_bf16 v[224:239], v[92:95], v[36:39], v[224:239]
    v_mfma_f32_32x32x16_bf16 v[240:255], v[92:95], v[52:55], v[240:255]
    s_add_u32 m0, s22, 7168
    s_add_u32 s26, s19, 229376
    buffer_load_dwordx4 v4, s[8:11], s26 offen lds
    global_load_dwordx4 v[92:95], v1, s[54:55] offset:1024 sc1
    s_waitcnt vmcnt(23)
    v_mfma_f32_32x32x16_bf16 v[128:143], v[96:99], v[40:43], v[128:143]
    v_mfma_f32_32x32x16_bf16 v[144:159], v[96:99], v[56:59], v[144:159]
    global_load_dwordx4 v[96:99], v1, s[48:49] offset:2048 sc1
    s_waitcnt vmcnt(23)
    v_mfma_f32_32x32x16_bf16 v[160:175], v[100:103], v[40:43], v[160:175]
    v_mfma_f32_32x32x16_bf16 v[176:191], v[100:103], v[56:59], v[176:191]
    global_load_dwordx4 v[100:103], v1, s[50:51] offset:2048 sc1
    s_waitcnt vmcnt(23)
    v_mfma_f32_32x32x16_bf16 v[192:207], v[104:107], v[40:43], v[192:207]
    v_mfma_f32_32x32x16_bf16 v[208:223], v[104:107], v[56:59], v[208:223]
    global_load_dwordx4 v[104:107], v1, s[52:53] offset:2048 sc1
    s_waitcnt vmcnt(23)
    v_mfma_f32_32x32x16_bf16 v[224:239], v[108:111], v[40:43], v[224:239]
    v_mfma_f32_32x32x16_bf16 v[240:255], v[108:111], v[56:59], v[240:255]
    global_load_dwordx4 v[108:111], v1, s[54:55] offset:2048 sc1
    s_waitcnt vmcnt(23)
    v_mfma_f32_32x32x16_bf16 v[128:143], v[112:115], v[44:47], v[128:143]
    v_mfma_f32_32x32x16_bf16 v[144:159], v[112:115], v[60:63], v[144:159]
    global_load_dwordx4 v[112:115], v1, s[48:49] offset:3072 sc1
    s_waitcnt vmcnt(23)
    v_mfma_f32_32x32x16_bf16 v[160:175], v[116:119], v[44:47], v[160:175]
    v_mfma_f32_32x32x16_bf16 v[176:191], v[116:119], v[60:63], v[176:191]
    global_load_dwordx4 v[116:119], v1, s[50:51] offset:3072 sc1
    s_waitcnt vmcnt(23)
    v_mfma_f32_32x32x16_bf16 v[192:207], v[120:123], v[44:47], v[192:207]
    v_mfma_f32_32x32x16_bf16 v[208:223], v[120:123], v[60:63], v[208:223]
    global_load_dwordx4 v[120:123], v1, s[52:53] offset:3072 sc1
    s_waitcnt vmcnt(23)
    v_mfma_f32_32x32x16_bf16 v[224:239], v[124:127], v[44:47], v[224:239]
    v_mfma_f32_32x32x16_bf16 v[240:255], v[124:127], v[60:63], v[240:255]
    global_load_dwordx4 v[124:127], v1, s[54:55] offset:3072 sc1
    s_add_u32 s19, s19, 128
    ds_read_b128 v[32:35], v12 offset:8192
    ds_read_b128 v[36:39], v13 offset:8192
    ds_read_b128 v[40:43], v14 offset:8192
    ds_read_b128 v[44:47], v15 offset:8192
    ds_read_b128 v[48:51], v12 offset:12288
    ds_read_b128 v[52:55], v13 offset:12288
    ds_read_b128 v[56:59], v14 offset:12288
    ds_read_b128 v[60:63], v15 offset:12288
    s_add_u32 s48, s48, 8192
    s_addc_u32 s49, s49, 0
    s_add_u32 s50, s50, 8192
    s_addc_u32 s51, s51, 0
    s_add_u32 s52, s52, 8192
    s_addc_u32 s53, s53, 0
    s_add_u32 s54, s54, 8192
    s_addc_u32 s55, s55, 0
    s_waitcnt lgkmcnt(0)
    s_waitcnt vmcnt(22)
    v_mfma_f32_32x32x16_bf16 v[128:143], v[64:67], v[32:35], v[128:143]
    v_mfma_f32_32x32x16_bf16 v[144:159], v[64:67], v[48:51], v[144:159]
    s_add_u32 m0, s22, 8192
    s_add_u32 s26, s19, 0
    buffer_load_dwordx4 v2, s[8:11], s26 offen lds
    global_load_dwordx4 v[64:67], v1, s[48:49] offset:-4096 sc1
    s_waitcnt vmcnt(22)
    v_mfma_f32_32x32x16_bf16 v[160:175], v[68:71], v[32:35], v[160:175]
    v_mfma_f32_32x32x16_bf16 v[176:191], v[68:71], v[48:51], v[176:191]
    s_add_u32 m0, s22, 9216
    s_add_u32 s26, s19, 32768
    buffer_load_dwordx4 v4, s[8:11], s26 offen lds
    global_load_dwordx4 v[68:71], v1, s[50:51] offset:-4096 sc1
    s_waitcnt vmcnt(22)
    v_mfma_f32_32x32x16_bf16 v[192:207], v[72:75], v[32:35], v[192:207]
    v_mfma_f32_32x32x16_bf16 v[208:223], v[72:75], v[48:51], v[208:223]
    s_add_u32 m0, s22, 10240
    s_add_u32 s26, s19, 65536
    buffer_load_dwordx4 v2, s[8:11], s26 offen lds
    global_load_dwordx4 v[72:75], v1, s[52:53] offset:-4096 sc1
    s_waitcnt vmcnt(22)
    v_mfma_f32_32x32x16_bf16 v[224:239], v[76:79], v[32:35], v[224:239]
    v_mfma_f32_32x32x16_bf16 v[240:255], v[76:79], v[48:51], v[240:255]
    s_add_u32 m0, s22, 11264
    s_add_u32 s26, s19, 98304
    buffer_load_dwordx4 v4, s[8:11], s26 offen lds
    global_load_dwordx4 v[76:79], v1, s[54:55] offset:-4096 sc1
    s_waitcnt vmcnt(22)
    v_mfma_f32_32x32x16_bf16 v[128:143], v[80:83], v[36:39], v[128:143]
    v_mfma_f32_32x32x16_bf16 v[144:159], v[80:83], v[52:55], v[144:159]
    s_add_u32 m0, s22, 12288
    s_add_u32 s26, s19, 131072
    buffer_load_dwordx4 v2, s[8:11], s26 offen lds
    global_load_dwordx4 v[80:83], v1, s[48:49] offset:-3072 sc1
    s_waitcnt vmcnt(22)
    v_mfma_f32_32x32x16_bf16 v[160:175], v[84:87], v[36:39], v[160:175]
    v_mfma_f32_32x32x16_bf16 v[176:191], v[84:87], v[52:55], v[176:191]
    s_add_u32 m0, s22, 13312
    s_add_u32 s26, s19, 163840
    buffer_load_dwordx4 v4, s[8:11], s26 offen lds
    global_load_dwordx4 v[84:87], v1, s[50:51] offset:-3072 sc1
    s_waitcnt vmcnt(22)
    v_mfma_f32_32x32x16_bf16 v[192:207], v[88:91], v[36:39], v[192:207]
    v_mfma_f32_32x32x16_bf16 v[208:223], v[88:91], v[52:55], v[208:223]
    s_add_u32 m0, s22, 14336
    s_add_u32 s26, s19, 196608
    buffer_load_dwordx4 v2, s[8:11], s26 offen lds
    global_load_dwordx4 v[88:91], v1, s[52:53] offset:-3072 sc1
    s_waitcnt vmcnt(22)
    v_mfma_f32_32x32x16_bf16 v[224:239], v[92:95], v[36:39], v[224:239]
    v_mfma_f32_32x32x16_bf16 v[240:255], v[92:95], v[52:55], v[240:255]
    s_add_u32 m0, s22, 15360
    s_add_u32 s26, s19, 229376
    buffer_load_dwordx4 v4, s[8:11], s26 offen lds
    global_load_dwordx4 v[92:95], v1, s[54:55] offset:-3072 sc1
    s_waitcnt vmcnt(23)
    v_mfma_f32_32x32x16_bf16 v[128:143], v[96:99], v[40:43], v[128:143]
    v_mfma_f32_32x32x16_bf16 v[144:159], v[96:99], v[56:59], v[144:159]
    global_load_dwordx4 v[96:99], v1, s[48:49] offset:-2048 sc1
    s_waitcnt vmcnt(23)
    v_mfma_f32_32x32x16_bf16 v[160:175], v[100:103], v[40:43], v[160:175]
    v_mfma_f32_32x32x16_bf16 v[176:191], v[100:103], v[56:59], v[176:191]
    global_load_dwordx4 v[100:103], v1, s[50:51] offset:-2048 sc1
    s_waitcnt vmcnt(23)
    v_mfma_f32_32x32x16_bf16 v[192:207], v[104:107], v[40:43], v[192:207]
    v_mfma_f32_32x32x16_bf16 v[208:223], v[104:107], v[56:59], v[208:223]
    global_load_dwordx4 v[104:107], v1, s[52:53] offset:-2048 sc1
    s_waitcnt vmcnt(23)
    v_mfma_f32_32x32x16_bf16 v[224:239], v[108:111], v[40:43], v[224:239]
    v_mfma_f32_32x32x16_bf16 v[240:255], v[108:111], v[56:59], v[240:255]
    global_load_dwordx4 v[108:111], v1, s[54:55] offset:-2048 sc1
    s_waitcnt vmcnt(23)
    v_mfma_f32_32x32x16_bf16 v[128:143], v[112:115], v[44:47], v[128:143]
    v_mfma_f32_32x32x16_bf16 v[144:159], v[112:115], v[60:63], v[144:159]
    global_load_dwordx4 v[112:115], v1, s[48:49] offset:-1024 sc1
    s_waitcnt vmcnt(23)
    v_mfma_f32_32x32x16_bf16 v[160:175], v[116:119], v[44:47], v[160:175]
    v_mfma_f32_32x32x16_bf16 v[176:191], v[116:119], v[60:63], v[176:191]
    global_load_dwordx4 v[116:119], v1, s[50:51] offset:-1024 sc1
    s_waitcnt vmcnt(23)
    v_mfma_f32_32x32x16_bf16 v[192:207], v[120:123], v[44:47], v[192:207]
    v_mfma_f32_32x32x16_bf16 v[208:223], v[120:123], v[60:63], v[208:223]
    global_load_dwordx4 v[120:123], v1, s[52:53] offset:-1024 sc1
    s_waitcnt vmcnt(23)
    v_mfma_f32_32x32x16_bf16 v[224:239], v[124:127], v[44:47], v[224:239]
    v_mfma_f32_32x32x16_bf16 v[240:255], v[124:127], v[60:63], v[240:255]
    global_load_dwordx4 v[124:127], v1, s[54:55] offset:-1024 sc1
    s_add_u32 s19, s19, 128
    s_sub_u32 s17, s17, 1
    s_cmp_eq_u32 s17, 3
    s_cbranch_scc1 G_wo
    s_cmp_eq_u32 s17, 1
    s_cbranch_scc1 G_z1
    s_cmp_lg_u32 s17, 0
    s_cbranch_scc1 G_loop
    s_branch G_done
G_wo:
    s_add_u32 m0, s23, 0
    s_add_u32 s26, s58, 0
    buffer_load_dwordx4 v3, s[44:47], s26 offen lds
    s_add_u32 m0, s23, 1024
    s_add_u32 s26, s58, 8192
    buffer_load_dwordx4 v3, s[44:47], s26 offen lds
    s_add_u32 m0, s23, 2048
    s_add_u32 s26, s58, 16384
    buffer_load_dwordx4 v3, s[44:47], s26 offen lds
    s_add_u32 m0, s23, 3072
    s_add_u32 s26, s58, 24576
    buffer_load_dwordx4 v3, s[44:47], s26 offen lds
    s_add_u32 m0, s23, 4096
    s_add_u32 s26, s58, 32768
    buffer_load_dwordx4 v3, s[44:47], s26 offen lds
    s_add_u32 m0, s23, 5120
    s_add_u32 s26, s58, 40960
    buffer_load_dwordx4 v3, s[44:47], s26 offen lds
    s_add_u32 m0, s23, 6144
    s_add_u32 s26, s58, 49152
    buffer_load_dwordx4 v3, s[44:47], s26 offen lds
    s_add_u32 m0, s23, 7168
    s_add_u32 s26, s58, 57344
    buffer_load_dwordx4 v3, s[44:47], s26 offen lds
    s_add_u32 m0, s23, 8192
    s_add_u32 s26, s58, 65536
    buffer_load_dwordx4 v3, s[44:47], s26 offen lds
    s_add_u32 m0, s23, 9216
    s_add_u32 s26, s58, 73728
    buffer_load_dwordx4 v3, s[44:47], s26 offen lds
    s_add_u32 m0, s23, 10240
    s_add_u32 s26, s58, 81920
    buffer_load_dwordx4 v3, s[44:47], s26 offen lds
    s_add_u32 m0, s23, 11264
    s_add_u32 s26, s58, 90112
    buffer_load_dwordx4 v3, s[44:47], s26 offen lds
    s_add_u32 m0, s23, 12288
    s_add_u32 s26, s58, 98304
    buffer_load_dwordx4 v3, s[44:47], s26 offen lds
    s_add_u32 m0, s23, 13312
    s_add_u32 s26, s58, 106496
    buffer_load_dwordx4 v3, s[44:47], s26 offen lds
    s_add_u32 m0, s23, 14336
    s_add_u32 s26, s58, 114688
    buffer_load_dwordx4 v3, s[44:47], s26 offen lds
    s_add_u32 m0, s23, 15360
    s_add_u32 s26, s58, 122880
    buffer_load_dwordx4 v3, s[44:47], s26 offen lds
    s_branch G_loop
G_z1:
    s_mov_b32 s10, 0
    s_lshl_b32 s26, s14, 7
    s_add_u32 s28, s28, s26
    s_addc_u32 s29, s29, 0
    global_load_ushort v10, v11, s[28:29]
    global_load_ushort v11, v11, s[28:29] offset:64
    global_load_dword v26, v27, s[4:5] sc1
    s_branch G_loop
G_done:
    s_setprio 0
    s_mul_i32 s26, s14, 56
    s_add_u32 s26, s26, s16
    s_lshl_b32 s26, s26, 11
    s_add_u32 s26, s26, 8454144
    s_add_u32 s24, s4, s26
    s_addc_u32 s25, s5, 0
    s_waitcnt vmcnt(0)
    s_setprio 1
    v_cmp_ne_u32 vcc, s60, v26
    s_cbranch_vccz G_pz1_d
G_pz1:
    global_load_dword v23, v27, s[4:5] sc1
    s_waitcnt vmcnt(0)
    v_cmp_ne_u32 vcc, s60, v23
    s_cbranch_vccz G_pz1_d
    s_sleep 8
    s_sub_u32 s98, s98, 1
    s_cmp_gt_i32 s98, 0
    s_cbranch_scc1 G_pz1
G_pz1_d:
    s_mov_b64 exec, -1
    s_setprio 0
    global_load_dwordx4 v[32:35], v1, s[24:25] sc1
    global_load_dwordx4 v[36:39], v1, s[24:25] offset:1024 sc1
    s_add_u32 s24, s24, 57344
    s_addc_u32 s25, s25, 0
    global_load_dwordx4 v[40:43], v1, s[24:25] sc1
    global_load_dwordx4 v[44:47], v1, s[24:25] offset:1024 sc1
    ds_write_b128 v16, v[160:163] offset:0
    ds_write_b128 v16, v[164:167] offset:1024
    ds_write_b128 v16, v[168:171] offset:2048
    ds_write_b128 v16, v[172:175] offset:3072
    ds_write_b128 v16, v[176:179] offset:4096
    ds_write_b128 v16, v[180:183] offset:5120
    ds_write_b128 v16, v[184:187] offset:6144
    ds_write_b128 v16, v[188:191] offset:7168
    ds_write_b128 v16, v[224:227] offset:8192
    ds_write_b128 v16, v[228:231] offset:9216
    ds_write_b128 v16, v[232:235] offset:10240
    ds_write_b128 v16, v[236:239] offset:11264
    ds_write_b128 v16, v[240:243] offset:12288
    ds_write_b128 v16, v[244:247] offset:13312
    ds_write_b128 v16, v[248:251] offset:14336
    ds_write_b128 v16, v[252:255] offset:15360
    ds_write_b32 v19, v8
    s_mul_i32 s26, s14, 176
    s_lshl_b32 s27, s16, 1
    s_add_u32 s26, s26, s27
    s_add_u32 s26, s26, 32
    s_lshl_b32 s26, s26, 10
    s_add_u32 s26, s26, 20971520
    s_add_u32 s24, s4, s26
    s_addc_u32 s25, s5, 0
    s_mul_i32 s26, s16, 37
    s_lshr_b32 s26, s26, 8
    s_mul_i32 s27, s26, 7
    s_sub_u32 s27, s16, s27
    s_lshl_b32 s18, s14, 2
    s_add_u32 s26, s26, s18
    s_lshl_b32 s26, s26, 5
    s_add_u32 s26, s26, s27
    s_lshl_b32 s26, s26, 2
    s_add_u32 s18, s26, 29147136
    s_setprio 1
G_r1:
    ds_read_b32 v9, v20
    s_waitcnt lgkmcnt(0)
    v_readfirstlane_b32 s26, v9
    s_nop 0
    s_cmp_ge_u32 s26, 1
    s_cbranch_scc1 G_r1_d
    s_sleep 3
    s_sub_u32 s98, s98, 1
    s_cmp_gt_i32 s98, 0
    s_cbranch_scc1 G_r1
G_r1_d:
    s_setprio 0
    ds_read_b128 v[224:227], v17 offset:8192
    ds_read_b128 v[228:231], v17 offset:9216
    ds_read_b128 v[232:235], v17 offset:10240
    ds_read_b128 v[236:239], v17 offset:11264
    ds_read_b128 v[240:243], v17 offset:12288
    ds_read_b128 v[244:247], v17 offset:13312
    ds_read_b128 v[248:251], v17 offset:14336
    ds_read_b128 v[252:255], v17 offset:15360
    ds_read_b128 v[160:163], v17 offset:0
    ds_read_b128 v[164:167], v17 offset:1024
    ds_read_b128 v[168:171], v17 offset:2048
    ds_read_b128 v[172:175], v17 offset:3072
    ds_read_b128 v[176:179], v17 offset:4096
    ds_read_b128 v[180:183], v17 offset:5120
    ds_read_b128 v[184:187], v17 offset:6144
    ds_read_b128 v[188:191], v17 offset:7168
    s_waitcnt lgkmcnt(8)
    s_setprio 1
    v_add_f32 v192, v192, v224
    v_add_f32 v193, v193, v225
    v_add_f32 v194, v194, v226
    v_add_f32 v195, v195, v227
    v_add_f32 v196, v196, v228
    v_add_f32 v197, v197, v229
    v_add_f32 v198, v198, v230
    v_add_f32 v199, v199, v231
    v_add_f32 v200, v200, v232
    v_add_f32 v201, v201, v233
    v_add_f32 v202, v202, v234
    v_add_f32 v203, v203, v235
    v_add_f32 v204, v204, v236
    v_add_f32 v205, v205, v237
    v_add_f32 v206, v206, v238
    v_add_f32 v207, v207, v239
    v_add_f32 v208, v208, v240
    v_add_f32 v209, v209, v241
    v_add_f32 v210, v210, v242
    v_add_f32 v211, v211, v243
    v_add_f32 v212, v212, v244
    v_add_f32 v213, v213, v245
    v_add_f32 v214, v214, v246
    v_add_f32 v215, v215, v247
    v_add_f32 v216, v216, v248
    v_add_f32 v217, v217, v249
    v_add_f32 v218, v218, v250
    v_add_f32 v219, v219, v251
    v_add_f32 v220, v220, v252
    v_add_f32 v221, v221, v253
    v_add_f32 v222, v222, v254
    v_add_f32 v223, v223, v255
    s_setprio 0
    s_waitcnt lgkmcnt(0)
    ds_write_b128 v17, v[192:195] offset:0
    ds_write_b128 v17, v[196:199] offset:1024
    ds_write_b128 v17, v[200:203] offset:2048
    ds_write_b128 v17, v[204:207] offset:3072
    ds_write_b128 v17, v[208:211] offset:4096
    ds_write_b128 v17, v[212:215] offset:5120
    ds_write_b128 v17, v[216:219] offset:6144
    ds_write_b128 v17, v[220:223] offset:7168
    ds_write_b32 v19, v22
    s_setprio 1
    v_add_f32 v128, v128, v160
    v_add_f32 v129, v129, v161
    v_add_f32 v130, v130, v162
    v_add_f32 v131, v131, v163
    v_add_f32 v132, v132, v164
    v_add_f32 v133, v133, v165
    v_add_f32 v134, v134, v166
    v_add_f32 v135, v135, v167
    v_add_f32 v136, v136, v168
    v_add_f32 v137, v137, v169
    v_add_f32 v138, v138, v170
    v_add_f32 v139, v139, v171
    v_add_f32 v140, v140, v172
    v_add_f32 v141, v141, v173
    v_add_f32 v142, v142, v174
    v_add_f32 v143, v143, v175
    v_add_f32 v144, v144, v176
    v_add_f32 v145, v145, v177
    v_add_f32 v146, v146, v178
    v_add_f32 v147, v147, v179
    v_add_f32 v148, v148, v180
    v_add_f32 v149, v149, v181
    v_add_f32 v150, v150, v182
    v_add_f32 v151, v151, v183
    v_add_f32 v152, v152, v184
    v_add_f32 v153, v153, v185
    v_add_f32 v154, v154, v186
    v_add_f32 v155, v155, v187
    v_add_f32 v156, v156, v188
    v_add_f32 v157, v157, v189
    v_add_f32 v158, v158, v190
    v_add_f32 v159, v159, v191
    s_setprio 0
    s_setprio 1
G_r2:
    ds_read_b32 v9, v21
    s_waitcnt lgkmcnt(0)
    v_readfirstlane_b32 s26, v9
    s_nop 0
    s_cmp_ge_u32 s26, 2
    s_cbranch_scc1 G_r2_d
    s_sleep 3
    s_sub_u32 s98, s98, 1
    s_cmp_gt_i32 s98, 0
    s_cbranch_scc1 G_r2
G_r2_d:
    s_setprio 0
    ds_read_b128 v[160:163], v18 offset:0
    ds_read_b128 v[164:167], v18 offset:1024
    ds_read_b128 v[168:171], v18 offset:2048
    ds_read_b128 v[172:175], v18 offset:3072
    ds_read_b128 v[176:179], v18 offset:4096
    ds_read_b128 v[180:183], v18 offset:5120
    ds_read_b128 v[184:187], v18 offset:6144
    ds_read_b128 v[188:191], v18 offset:7168
    s_mov_b64 exec, 1
    ds_add_u32 v7, v8
    s_mov_b64 exec, -1
    s_waitcnt vmcnt(0) lgkmcnt(0)
    s_setprio 1
    v_lshlrev_b32 v10, 16, v10
    v_lshlrev_b32 v11, 16, v11
    v_add_f32 v128, v128, v160
    v_add_f32 v129, v129, v161
    v_lshlrev_b32 v48, 16, v32
    v_and_b32 v49, 0xffff0000, v32
    v_add_f32 v128, v128, v10
    v_add_f32 v129, v129, v10
    v_mul_f32 v128, v128, v48
    v_mul_f32 v129, v129, v49
    v_cvt_pk_bf16_f32 v32, v128, v129
    v_add_f32 v130, v130, v162
    v_add_f32 v131, v131, v163
    v_lshlrev_b32 v48, 16, v33
    v_and_b32 v49, 0xffff0000, v33
    v_add_f32 v130, v130, v10
    v_add_f32 v131, v131, v10
    v_mul_f32 v130, v130, v48
    v_mul_f32 v131, v131, v49
    v_cvt_pk_bf16_f32 v33, v130, v131
    v_add_f32 v132, v132, v164
    v_add_f32 v133, v133, v165
    v_lshlrev_b32 v48, 16, v34
    v_and_b32 v49, 0xffff0000, v34
    v_add_f32 v132, v132, v10
    v_add_f32 v133, v133, v10
    v_mul_f32 v132, v132, v48
    v_mul_f32 v133, v133, v49
    v_cvt_pk_bf16_f32 v34, v132, v133
    v_add_f32 v134, v134, v166
    v_add_f32 v135, v135, v167
    v_lshlrev_b32 v48, 16, v35
    v_and_b32 v49, 0xffff0000, v35
    v_add_f32 v134, v134, v10
    v_add_f32 v135, v135, v10
    v_mul_f32 v134, v134, v48
    v_mul_f32 v135, v135, v49
    v_cvt_pk_bf16_f32 v35, v134, v135
    v_add_f32 v136, v136, v168
    v_add_f32 v137, v137, v169
    v_lshlrev_b32 v48, 16, v36
    v_and_b32 v49, 0xffff0000, v36
    v_add_f32 v136, v136, v10
    v_add_f32 v137, v137, v10
    v_mul_f32 v136, v136, v48
    v_mul_f32 v137, v137, v49
    v_cvt_pk_bf16_f32 v36, v136, v137
    v_add_f32 v138, v138, v170
    v_add_f32 v139, v139, v171
    v_lshlrev_b32 v48, 16, v37
    v_and_b32 v49, 0xffff0000, v37
    v_add_f32 v138, v138, v10
    v_add_f32 v139, v139, v10
    v_mul_f32 v138, v138, v48
    v_mul_f32 v139, v139, v49
    v_cvt_pk_bf16_f32 v37, v138, v139
    v_add_f32 v140, v140, v172
    v_add_f32 v141, v141, v173
    v_lshlrev_b32 v48, 16, v38
    v_and_b32 v49, 0xffff0000, v38
    v_add_f32 v140, v140, v10
    v_add_f32 v141, v141, v10
    v_mul_f32 v140, v140, v48
    v_mul_f32 v141, v141, v49
    v_cvt_pk_bf16_f32 v38, v140, v141
    v_add_f32 v142, v142, v174
    v_add_f32 v143, v143, v175
    v_lshlrev_b32 v48, 16, v39
    v_and_b32 v49, 0xffff0000, v39
    v_add_f32 v142, v142, v10
    v_add_f32 v143, v143, v10
    v_mul_f32 v142, v142, v48
    v_mul_f32 v143, v143, v49
    v_cvt_pk_bf16_f32 v39, v142, v143
    global_store_dwordx4 v1, v[32:35], s[24:25] sc1
    global_store_dwordx4 v1, v[36:39], s[24:25] offset:1024 sc1
    s_add_u32 s24, s24, 90112
    s_addc_u32 s25, s25, 0
    v_add_f32 v144, v144, v176
    v_add_f32 v145, v145, v177
    v_lshlrev_b32 v48, 16, v40
    v_and_b32 v49, 0xffff0000, v40
    v_add_f32 v144, v144, v11
    v_add_f32 v145, v145, v11
    v_mul_f32 v144, v144, v48
    v_mul_f32 v145, v145, v49
    v_cvt_pk_bf16_f32 v40, v144, v145
    v_add_f32 v146, v146, v178
    v_add_f32 v147, v147, v179
    v_lshlrev_b32 v48, 16, v41
    v_and_b32 v49, 0xffff0000, v41
    v_add_f32 v146, v146, v11
    v_add_f32 v147, v147, v11
    v_mul_f32 v146, v146, v48
    v_mul_f32 v147, v147, v49
    v_cvt_pk_bf16_f32 v41, v146, v147
    v_add_f32 v148, v148, v180
    v_add_f32 v149, v149, v181
    v_lshlrev_b32 v48, 16, v42
    v_and_b32 v49, 0xffff0000, v42
    v_add_f32 v148, v148, v11
    v_add_f32 v149, v149, v11
    v_mul_f32 v148, v148, v48
    v_mul_f32 v149, v149, v49
    v_cvt_pk_bf16_f32 v42, v148, v149
    v_add_f32 v150, v150, v182
    v_add_f32 v151, v151, v183
    v_lshlrev_b32 v48, 16, v43
    v_and_b32 v49, 0xffff0000, v43
    v_add_f32 v150, v150, v11
    v_add_f32 v151, v151, v11
    v_mul_f32 v150, v150, v48
    v_mul_f32 v151, v151, v49
    v_cvt_pk_bf16_f32 v43, v150, v151
    v_add_f32 v152, v152, v184
    v_add_f32 v153, v153, v185
    v_lshlrev_b32 v48, 16, v44
    v_and_b32 v49, 0xffff0000, v44
    v_add_f32 v152, v152, v11
    v_add_f32 v153, v153, v11
    v_mul_f32 v152, v152, v48
    v_mul_f32 v153, v153, v49
    v_cvt_pk_bf16_f32 v44, v152, v153
    v_add_f32 v154, v154, v186
    v_add_f32 v155, v155, v187
    v_lshlrev_b32 v48, 16, v45
    v_and_b32 v49, 0xffff0000, v45
    v_add_f32 v154, v154, v11
    v_add_f32 v155, v155, v11
    v_mul_f32 v154, v154, v48
    v_mul_f32 v155, v155, v49
    v_cvt_pk_bf16_f32 v45, v154, v155
    v_add_f32 v156, v156, v188
    v_add_f32 v157, v157, v189
    v_lshlrev_b32 v48, 16, v46
    v_and_b32 v49, 0xffff0000, v46
    v_add_f32 v156, v156, v11
    v_add_f32 v157, v157, v11
    v_mul_f32 v156, v156, v48
    v_mul_f32 v157, v157, v49
    v_cvt_pk_bf16_f32 v46, v156, v157
    v_add_f32 v158, v158, v190
    v_add_f32 v159, v159, v191
    v_lshlrev_b32 v48, 16, v47
    v_and_b32 v49, 0xffff0000, v47
    v_add_f32 v158, v158, v11
    v_add_f32 v159, v159, v11
    v_mul_f32 v158, v158, v48
    v_mul_f32 v159, v159, v49
    v_cvt_pk_bf16_f32 v47, v158, v159
    global_store_dwordx4 v1, v[40:43], s[24:25] sc1
    global_store_dwordx4 v1, v[44:47], s[24:25] offset:1024 sc1
    v_mov_b32 v2, s18
    v_mov_b32 v23, s60
    v_subrev_u32 v14, 65536, v24
    v_subrev_u32 v15, 65536, v25
    s_setprio 0
    s_mov_b32 s21, 0
G_stage:
    ds_read_b64_tr_b16 v[128:129], v14 offset:0
    ds_read_b64_tr_b16 v[130:131], v14 offset:1024
    ds_read_b64_tr_b16 v[132:133], v15 offset:0
    ds_read_b64_tr_b16 v[134:135], v15 offset:1024
    ds_read_b64_tr_b16 v[136:137], v14 offset:2048
    ds_read_b64_tr_b16 v[138:139], v14 offset:3072
    ds_read_b64_tr_b16 v[140:141], v15 offset:2048
    ds_read_b64_tr_b16 v[142:143], v15 offset:3072
    ds_read_b64_tr_b16 v[144:145], v14 offset:4096
    ds_read_b64_tr_b16 v[146:147], v14 offset:5120
    ds_read_b64_tr_b16 v[148:149], v15 offset:4096
    ds_read_b64_tr_b16 v[150:151], v15 offset:5120
    ds_read_b64_tr_b16 v[152:153], v14 offset:6144
    ds_read_b64_tr_b16 v[154:155], v14 offset:7168
    ds_read_b64_tr_b16 v[156:157], v15 offset:6144
    ds_read_b64_tr_b16 v[158:159], v15 offset:7168
    ds_read_b64_tr_b16 v[160:161], v14 offset:8192
    ds_read_b64_tr_b16 v[162:163], v14 offset:9216
    ds_read_b64_tr_b16 v[164:165], v15 offset:8192
    ds_read_b64_tr_b16 v[166:167], v15 offset:9216
    ds_read_b64_tr_b16 v[168:169], v14 offset:10240
    ds_read_b64_tr_b16 v[170:171], v14 offset:11264
    ds_read_b64_tr_b16 v[172:173], v15 offset:10240
    ds_read_b64_tr_b16 v[174:175], v15 offset:11264
    ds_read_b64_tr_b16 v[176:177], v14 offset:12288
    ds_read_b64_tr_b16 v[178:179], v14 offset:13312
    ds_read_b64_tr_b16 v[180:181], v15 offset:12288
    ds_read_b64_tr_b16 v[182:183], v15 offset:13312
    ds_read_b64_tr_b16 v[184:185], v14 offset:14336
    ds_read_b64_tr_b16 v[186:187], v14 offset:15360
    ds_read_b64_tr_b16 v[188:189], v15 offset:14336
    ds_read_b64_tr_b16 v[190:191], v15 offset:15360
    s_load_dwordx2 s[32:33], s[0:1], 0
    s_load_dwordx2 s[34:35], s[0:1], 64
    s_add_u32 s58, s58, 131072
    s_cmp_eq_u32 s21, 1
    s_cbranch_scc1 G_st2
    s_waitcnt vmcnt(0)
    s_mov_b64 exec, 1
    global_store_dword v2, v23, s[4:5] sc1
    s_mov_b64 exec, -1
    s_setprio 1
G_free:
    ds_read_b32 v9, v7
    s_waitcnt lgkmcnt(0)
    v_readfirstlane_b32 s26, v9
    s_nop 0
    s_cmp_ge_u32 s26, 4
    s_cbranch_scc1 G_free_d
    s_sleep 3
    s_sub_u32 s98, s98, 1
    s_cmp_gt_i32 s98, 0
    s_cbranch_scc1 G_free
G_free_d:
    s_setprio 0
G_st2:
    s_waitcnt lgkmcnt(0)
    s_add_u32 m0, s22, 0
    s_add_u32 s26, s58, 0
    buffer_load_dwordx4 v3, s[44:47], s26 offen lds
    s_add_u32 m0, s22, 1024
    s_add_u32 s26, s58, 8192
    buffer_load_dwordx4 v3, s[44:47], s26 offen lds
    s_add_u32 m0, s22, 2048
    s_add_u32 s26, s58, 16384
    buffer_load_dwordx4 v3, s[44:47], s26 offen lds
    s_add_u32 m0, s22, 3072
    s_add_u32 s26, s58, 24576
    buffer_load_dwordx4 v3, s[44:47], s26 offen lds
    s_add_u32 m0, s22, 4096
    s_add_u32 s26, s58, 32768
    buffer_load_dwordx4 v3, s[44:47], s26 offen lds
    s_add_u32 m0, s22, 5120
    s_add_u32 s26, s58, 40960
    buffer_load_dwordx4 v3, s[44:47], s26 offen lds
    s_add_u32 m0, s22, 6144
    s_add_u32 s26, s58, 49152
    buffer_load_dwordx4 v3, s[44:47], s26 offen lds
    s_add_u32 m0, s22, 7168
    s_add_u32 s26, s58, 57344
    buffer_load_dwordx4 v3, s[44:47], s26 offen lds
    s_add_u32 m0, s22, 8192
    s_add_u32 s26, s58, 65536
    buffer_load_dwordx4 v3, s[44:47], s26 offen lds
    s_add_u32 m0, s22, 9216
    s_add_u32 s26, s58, 73728
    buffer_load_dwordx4 v3, s[44:47], s26 offen lds
    s_add_u32 m0, s22, 10240
    s_add_u32 s26, s58, 81920
    buffer_load_dwordx4 v3, s[44:47], s26 offen lds
    s_add_u32 m0, s22, 11264
    s_add_u32 s26, s58, 90112
    buffer_load_dwordx4 v3, s[44:47], s26 offen lds
    s_add_u32 m0, s23, 0
    s_add_u32 s26, s57, 0
    buffer_load_dwordx4 v3, s[40:43], s26 offen lds
    s_add_u32 m0, s23, 1024
    s_add_u32 s26, s57, 8192
    buffer_load_dwordx4 v3, s[40:43], s26 offen lds
    s_add_u32 m0, s23, 2048
    s_add_u32 s26, s57, 16384
    buffer_load_dwordx4 v3, s[40:43], s26 offen lds
    s_add_u32 m0, s23, 3072
    s_add_u32 s26, s57, 24576
    buffer_load_dwordx4 v3, s[40:43], s26 offen lds
    s_add_u32 m0, s23, 4096
    s_add_u32 s26, s57, 32768
    buffer_load_dwordx4 v3, s[40:43], s26 offen lds
    s_add_u32 m0, s23, 5120
    s_add_u32 s26, s57, 40960
    buffer_load_dwordx4 v3, s[40:43], s26 offen lds
    s_add_u32 m0, s23, 6144
    s_add_u32 s26, s57, 49152
    buffer_load_dwordx4 v3, s[40:43], s26 offen lds
    s_add_u32 m0, s23, 7168
    s_add_u32 s26, s57, 57344
    buffer_load_dwordx4 v3, s[40:43], s26 offen lds
    s_add_u32 m0, s23, 8192
    s_add_u32 s26, s57, 65536
    buffer_load_dwordx4 v3, s[40:43], s26 offen lds
    s_add_u32 m0, s23, 9216
    s_add_u32 s26, s57, 73728
    buffer_load_dwordx4 v3, s[40:43], s26 offen lds
    s_add_u32 m0, s23, 10240
    s_add_u32 s26, s57, 81920
    buffer_load_dwordx4 v3, s[40:43], s26 offen lds
    s_add_u32 m0, s23, 11264
    s_add_u32 s26, s57, 90112
    buffer_load_dwordx4 v3, s[40:43], s26 offen lds
    s_add_u32 m0, s23, 12288
    s_add_u32 s26, s57, 98304
    buffer_load_dwordx4 v3, s[40:43], s26 offen lds
    s_add_u32 m0, s23, 13312
    s_add_u32 s26, s57, 106496
    buffer_load_dwordx4 v3, s[40:43], s26 offen lds
    s_add_u32 m0, s23, 14336
    s_add_u32 s26, s57, 114688
    buffer_load_dwordx4 v3, s[40:43], s26 offen lds
    s_add_u32 m0, s23, 15360
    s_add_u32 s26, s57, 122880
    buffer_load_dwordx4 v3, s[40:43], s26 offen lds
    s_mul_i32 s38, s13, 14
    s_add_u32 s38, s38, 32
    s_lshr_b32 s27, s13, 1
    s_lshl_b32 s26, s61, 1
    s_add_u32 s26, s26, s27
    s_mul_i32 s27, s26, 88
    s_add_u32 s27, s27, s38
    s_lshl_b32 s27, s27, 10
    s_add_u32 s27, s27, 20975616
    s_add_u32 s64, s4, s27
    s_addc_u32 s65, s5, 0
    s_xor_b32 s26, s26, 1
    s_mul_i32 s27, s26, 88
    s_add_u32 s27, s27, s38
    s_lshl_b32 s27, s27, 10
    s_add_u32 s27, s27, 20975616
    s_add_u32 s66, s4, s27
    s_addc_u32 s67, s5, 0
    s_lshl_b32 s26, s61, 2
    s_add_u32 s26, s26, s13
    s_lshl_b32 s26, s26, 7
    s_add_u32 s26, s26, 29147136
    s_setprio 1
    v_lshl_add_u32 v2, v0, 2, s26
    v_subrev_u32 v13, 16384, v2
    v_and_b32 v6, 31, v0
    v_lshlrev_b32 v6, 10, v6
    v_lshrrev_b32 v9, 5, v0
    v_lshl_add_u32 v6, v9, 4, v6
    s_lshl_b32 s26, s61, 1
    s_lshr_b32 s27, s13, 1
    s_add_u32 s26, s26, s27
    s_lshl_b32 s26, s26, 15
    s_lshl_b32 s27, s62, 7
    s_add_u32 s26, s26, s27
    s_and_b32 s27, s13, 1
    s_lshl_b32 s27, s27, 6
    s_add_u32 s26, s26, s27
    v_add_u32 v6, s26, v6
    v_add_u32 v4, s22, v1
    s_xor_b32 s26, s22, 16384
    v_add_u32 v10, s26, v1
    s_xor_b32 s26, s22, 32768
    v_add_u32 v11, s26, v1
    s_xor_b32 s26, s22, 49152
    v_add_u32 v12, s26, v1
    v_mov_b32 v7, 149508
    s_mov_b64 exec, 127
Y_poll:
    global_load_dword v9, v2, s[4:5] sc1
    s_waitcnt vmcnt(0)
    v_cmp_ne_u32 vcc, s60, v9
    s_cbranch_vccz Y_poll_d
    s_sleep 16
    s_sub_u32 s98, s98, 1
    s_cmp_gt_i32 s98, 0
    s_cbranch_scc1 Y_poll
Y_poll_d:
    s_mov_b64 exec, -1
    s_setprio 0
    global_load_dwordx4 v[80:83], v1, s[64:65] offset:-4096 sc1
    global_load_dwordx4 v[84:87], v1, s[66:67] offset:-4096 sc1
    global_load_dwordx4 v[88:91], v1, s[64:65] offset:-3072 sc1
    global_load_dwordx4 v[92:95], v1, s[66:67] offset:-3072 sc1
    global_load_dwordx4 v[96:99], v1, s[64:65] offset:-2048 sc1
    global_load_dwordx4 v[100:103], v1, s[66:67] offset:-2048 sc1
    global_load_dwordx4 v[104:107], v1, s[64:65] offset:-1024 sc1
    global_load_dwordx4 v[108:111], v1, s[66:67] offset:-1024 sc1
    global_load_dwordx4 v[112:115], v1, s[64:65] offset:0 sc1
    global_load_dwordx4 v[116:119], v1, s[66:67] offset:0 sc1
    global_load_dwordx4 v[120:123], v1, s[64:65] offset:1024 sc1
    global_load_dwordx4 v[124:127], v1, s[66:67] offset:1024 sc1
    global_load_dwordx4 v[240:243], v1, s[64:65] offset:2048 sc1
    global_load_dwordx4 v[244:247], v1, s[66:67] offset:2048 sc1
    global_load_dwordx4 v[248:251], v1, s[64:65] offset:3072 sc1
    global_load_dwordx4 v[252:255], v1, s[66:67] offset:3072 sc1
    ds_read_b64_tr_b16 v[192:193], v24 offset:0
    ds_read_b64_tr_b16 v[194:195], v24 offset:1024
    ds_read_b64_tr_b16 v[196:197], v25 offset:0
    ds_read_b64_tr_b16 v[198:199], v25 offset:1024
    ds_read_b64_tr_b16 v[200:201], v24 offset:2048
    ds_read_b64_tr_b16 v[202:203], v24 offset:3072
    ds_read_b64_tr_b16 v[204:205], v25 offset:2048
    ds_read_b64_tr_b16 v[206:207], v25 offset:3072
    ds_read_b64_tr_b16 v[208:209], v24 offset:4096
    ds_read_b64_tr_b16 v[210:211], v24 offset:5120
    ds_read_b64_tr_b16 v[212:213], v25 offset:4096
    ds_read_b64_tr_b16 v[214:215], v25 offset:5120
    ds_read_b64_tr_b16 v[216:217], v24 offset:6144
    ds_read_b64_tr_b16 v[218:219], v24 offset:7168
    ds_read_b64_tr_b16 v[220:221], v25 offset:6144
    ds_read_b64_tr_b16 v[222:223], v25 offset:7168
    ds_read_b64_tr_b16 v[224:225], v24 offset:8192
    ds_read_b64_tr_b16 v[226:227], v24 offset:9216
    ds_read_b64_tr_b16 v[228:229], v25 offset:8192
    ds_read_b64_tr_b16 v[230:231], v25 offset:9216
    ds_read_b64_tr_b16 v[232:233], v24 offset:10240
    ds_read_b64_tr_b16 v[234:235], v24 offset:11264
    ds_read_b64_tr_b16 v[236:237], v25 offset:10240
    ds_read_b64_tr_b16 v[238:239], v25 offset:11264
    s_waitcnt vmcnt(14)
    v_mfma_f32_32x32x16_bf16 v[16:31], v[128:131], v[80:83], 0
    v_mfma_f32_32x32x16_bf16 v[32:47], v[132:135], v[80:83], 0
    v_mfma_f32_32x32x16_bf16 v[48:63], v[128:131], v[84:87], 0
    v_mfma_f32_32x32x16_bf16 v[64:79], v[132:135], v[84:87], 0
    s_add_u32 s64, s64, 8192
    s_addc_u32 s65, s65, 0
    s_add_u32 s66, s66, 8192
    s_addc_u32 s67, s67, 0
    global_load_dwordx4 v[80:83], v1, s[64:65] offset:-4096 sc1
    global_load_dwordx4 v[84:87], v1, s[66:67] offset:-4096 sc1
    s_waitcnt vmcnt(14)
    v_mfma_f32_32x32x16_bf16 v[16:31], v[136:139], v[88:91], v[16:31]
    v_mfma_f32_32x32x16_bf16 v[32:47], v[140:143], v[88:91], v[32:47]
    v_mfma_f32_32x32x16_bf16 v[48:63], v[136:139], v[92:95], v[48:63]
    v_mfma_f32_32x32x16_bf16 v[64:79], v[140:143], v[92:95], v[64:79]
    global_load_dwordx4 v[88:91], v1, s[64:65] offset:-3072 sc1
    global_load_dwordx4 v[92:95], v1, s[66:67] offset:-3072 sc1
    s_waitcnt vmcnt(14)
    v_mfma_f32_32x32x16_bf16 v[16:31], v[144:147], v[96:99], v[16:31]
    v_mfma_f32_32x32x16_bf16 v[32:47], v[148:151], v[96:99], v[32:47]
    v_mfma_f32_32x32x16_bf16 v[48:63], v[144:147], v[100:103], v[48:63]
    v_mfma_f32_32x32x16_bf16 v[64:79], v[148:151], v[100:103], v[64:79]
    global_load_dwordx4 v[96:99], v1, s[64:65] offset:-2048 sc1
    global_load_dwordx4 v[100:103], v1, s[66:67] offset:-2048 sc1
    s_waitcnt vmcnt(14)
    v_mfma_f32_32x32x16_bf16 v[16:31], v[152:155], v[104:107], v[16:31]
    v_mfma_f32_32x32x16_bf16 v[32:47], v[156:159], v[104:107], v[32:47]
    v_mfma_f32_32x32x16_bf16 v[48:63], v[152:155], v[108:111], v[48:63]
    v_mfma_f32_32x32x16_bf16 v[64:79], v[156:159], v[108:111], v[64:79]
    global_load_dwordx4 v[104:107], v1, s[64:65] offset:-1024 sc1
    global_load_dwordx4 v[108:111], v1, s[66:67] offset:-1024 sc1
    s_waitcnt vmcnt(14)
    v_mfma_f32_32x32x16_bf16 v[16:31], v[160:163], v[112:115], v[16:31]
    v_mfma_f32_32x32x16_bf16 v[32:47], v[164:167], v[112:115], v[32:47]
    v_mfma_f32_32x32x16_bf16 v[48:63], v[160:163], v[116:119], v[48:63]
    v_mfma_f32_32x32x16_bf16 v[64:79], v[164:167], v[116:119], v[64:79]
    global_load_dwordx4 v[112:115], v1, s[64:65] offset:0 sc1
    global_load_dwordx4 v[116:119], v1, s[66:67] offset:0 sc1
    s_waitcnt vmcnt(14)
    v_mfma_f32_32x32x16_bf16 v[16:31], v[168:171], v[120:123], v[16:31]
    v_mfma_f32_32x32x16_bf16 v[32:47], v[172:175], v[120:123], v[32:47]
    v_mfma_f32_32x32x16_bf16 v[48:63], v[168:171], v[124:127], v[48:63]
    v_mfma_f32_32x32x16_bf16 v[64:79], v[172:175], v[124:127], v[64:79]
    global_load_dwordx4 v[120:123], v1, s[64:65] offset:1024 sc1
    global_load_dwordx4 v[124:127], v1, s[66:67] offset:1024 sc1
    s_waitcnt vmcnt(14)
    v_mfma_f32_32x32x16_bf16 v[16:31], v[176:179], v[240:243], v[16:31]
    v_mfma_f32_32x32x16_bf16 v[32:47], v[180:183], v[240:243], v[32:47]
    v_mfma_f32_32x32x16_bf16 v[48:63], v[176:179], v[244:247], v[48:63]
    v_mfma_f32_32x32x16_bf16 v[64:79], v[180:183], v[244:247], v[64:79]
    s_waitcnt vmcnt(12)
    v_mfma_f32_32x32x16_bf16 v[16:31], v[184:187], v[248:251], v[16:31]
    v_mfma_f32_32x32x16_bf16 v[32:47], v[188:191], v[248:251], v[32:47]
    v_mfma_f32_32x32x16_bf16 v[48:63], v[184:187], v[252:255], v[48:63]
    v_mfma_f32_32x32x16_bf16 v[64:79], v[188:191], v[252:255], v[64:79]
    s_waitcnt vmcnt(10)
    s_waitcnt lgkmcnt(0)
    ds_read_b64_tr_b16 v[128:129], v14 offset:0
    ds_read_b64_tr_b16 v[130:131], v14 offset:1024
    ds_read_b64_tr_b16 v[132:133], v15 offset:0
    ds_read_b64_tr_b16 v[134:135], v15 offset:1024
    ds_read_b64_tr_b16 v[136:137], v14 offset:2048
    ds_read_b64_tr_b16 v[138:139], v14 offset:3072
    ds_read_b64_tr_b16 v[140:141], v15 offset:2048
    ds_read_b64_tr_b16 v[142:143], v15 offset:3072
    ds_read_b64_tr_b16 v[144:145], v14 offset:4096
    ds_read_b64_tr_b16 v[146:147], v14 offset:5120
    ds_read_b64_tr_b16 v[148:149], v15 offset:4096
    ds_read_b64_tr_b16 v[150:151], v15 offset:5120
    ds_read_b64_tr_b16 v[152:153], v14 offset:6144
    ds_read_b64_tr_b16 v[154:155], v14 offset:7168
    ds_read_b64_tr_b16 v[156:157], v15 offset:6144
    ds_read_b64_tr_b16 v[158:159], v15 offset:7168
    ds_read_b64_tr_b16 v[160:161], v14 offset:8192
    ds_read_b64_tr_b16 v[162:163], v14 offset:9216
    ds_read_b64_tr_b16 v[164:165], v15 offset:8192
    ds_read_b64_tr_b16 v[166:167], v15 offset:9216
    ds_read_b64_tr_b16 v[168:169], v14 offset:10240
    ds_read_b64_tr_b16 v[170:171], v14 offset:11264
    ds_read_b64_tr_b16 v[172:173], v15 offset:10240
    ds_read_b64_tr_b16 v[174:175], v15 offset:11264
    ds_read_b64_tr_b16 v[176:177], v14 offset:12288
    ds_read_b64_tr_b16 v[178:179], v14 offset:13312
    ds_read_b64_tr_b16 v[180:181], v15 offset:12288
    ds_read_b64_tr_b16 v[182:183], v15 offset:13312
    ds_read_b64_tr_b16 v[184:185], v14 offset:14336
    ds_read_b64_tr_b16 v[186:187], v14 offset:15360
    ds_read_b64_tr_b16 v[188:189], v15 offset:14336
    ds_read_b64_tr_b16 v[190:191], v15 offset:15360
    v_mfma_f32_32x32x16_bf16 v[16:31], v[192:195], v[80:83], v[16:31]
    v_mfma_f32_32x32x16_bf16 v[32:47], v[196:199], v[80:83], v[32:47]
    v_mfma_f32_32x32x16_bf16 v[48:63], v[192:195], v[84:87], v[48:63]
    v_mfma_f32_32x32x16_bf16 v[64:79], v[196:199], v[84:87], v[64:79]
    s_waitcnt vmcnt(8)
    v_mfma_f32_32x32x16_bf16 v[16:31], v[200:203], v[88:91], v[16:31]
    v_mfma_f32_32x32x16_bf16 v[32:47], v[204:207], v[88:91], v[32:47]
    v_mfma_f32_32x32x16_bf16 v[48:63], v[200:203], v[92:95], v[48:63]
    v_mfma_f32_32x32x16_bf16 v[64:79], v[204:207], v[92:95], v[64:79]
    s_waitcnt vmcnt(6)
    v_mfma_f32_32x32x16_bf16 v[16:31], v[208:211], v[96:99], v[16:31]
    v_mfma_f32_32x32x16_bf16 v[32:47], v[212:215], v[96:99], v[32:47]
    v_mfma_f32_32x32x16_bf16 v[48:63], v[208:211], v[100:103], v[48:63]
    v_mfma_f32_32x32x16_bf16 v[64:79], v[212:215], v[100:103], v[64:79]
    s_waitcnt vmcnt(4)
    v_mfma_f32_32x32x16_bf16 v[16:31], v[216:219], v[104:107], v[16:31]
    v_mfma_f32_32x32x16_bf16 v[32:47], v[220:223], v[104:107], v[32:47]
    v_mfma_f32_32x32x16_bf16 v[48:63], v[216:219], v[108:111], v[48:63]
    v_mfma_f32_32x32x16_bf16 v[64:79], v[220:223], v[108:111], v[64:79]
    s_waitcnt vmcnt(2)
    v_mfma_f32_32x32x16_bf16 v[16:31], v[224:227], v[112:115], v[16:31]
    v_mfma_f32_32x32x16_bf16 v[32:47], v[228:231], v[112:115], v[32:47]
    v_mfma_f32_32x32x16_bf16 v[48:63], v[224:227], v[116:119], v[48:63]
    v_mfma_f32_32x32x16_bf16 v[64:79], v[228:231], v[116:119], v[64:79]
    s_waitcnt vmcnt(0)
    v_mfma_f32_32x32x16_bf16 v[16:31], v[232:235], v[120:123], v[16:31]
    v_mfma_f32_32x32x16_bf16 v[32:47], v[236:239], v[120:123], v[32:47]
    v_mfma_f32_32x32x16_bf16 v[48:63], v[232:235], v[124:127], v[48:63]
    v_mfma_f32_32x32x16_bf16 v[64:79], v[236:239], v[124:127], v[64:79]
    s_lshl_b32 s38, s13, 3
    s_lshr_b32 s27, s13, 1
    s_lshl_b32 s26, s61, 1
    s_add_u32 s26, s26, s27
    s_mul_i32 s27, s26, 88
    s_add_u32 s27, s27, s38
    s_lshl_b32 s27, s27, 10
    s_add_u32 s27, s27, 20975616
    s_add_u32 s64, s4, s27
    s_addc_u32 s65, s5, 0
    s_xor_b32 s26, s26, 1
    s_mul_i32 s27, s26, 88
    s_add_u32 s27, s27, s38
    s_lshl_b32 s27, s27, 10
    s_add_u32 s27, s27, 20975616
    s_add_u32 s66, s4, s27
    s_addc_u32 s67, s5, 0
    global_load_dwordx4 v[192:195], v6, s[32:33]
    global_load_dwordx4 v[196:199], v6, s[32:33] offset:32
    s_setprio 1
    s_mov_b64 exec, 255
O_poll:
    global_load_dword v9, v13, s[4:5] sc1
    s_waitcnt vmcnt(0)
    v_cmp_ne_u32 vcc, s60, v9
    s_cbranch_vccz O_poll_d
    s_sleep 3
    s_sub_u32 s98, s98, 1
    s_cmp_gt_i32 s98, 0
    s_cbranch_scc1 O_poll
O_poll_d:
    s_mov_b64 exec, -1
    global_load_dwordx4 v[80:83], v1, s[64:65] offset:-4096 sc1
    global_load_dwordx4 v[84:87], v1, s[66:67] offset:-4096 sc1
    global_load_dwordx4 v[88:91], v1, s[64:65] offset:-3072 sc1
    global_load_dwordx4 v[92:95], v1, s[66:67] offset:-3072 sc1
    global_load_dwordx4 v[96:99], v1, s[64:65] offset:-2048 sc1
    global_load_dwordx4 v[100:103], v1, s[66:67] offset:-2048 sc1
    global_load_dwordx4 v[104:107], v1, s[64:65] offset:-1024 sc1
    global_load_dwordx4 v[108:111], v1, s[66:67] offset:-1024 sc1
    global_load_dwordx4 v[112:115], v1, s[64:65] offset:0 sc1
    global_load_dwordx4 v[116:119], v1, s[66:67] offset:0 sc1
    global_load_dwordx4 v[120:123], v1, s[64:65] offset:1024 sc1
    global_load_dwordx4 v[124:127], v1, s[66:67] offset:1024 sc1
    global_load_dwordx4 v[240:243], v1, s[64:65] offset:2048 sc1
    global_load_dwordx4 v[244:247], v1, s[66:67] offset:2048 sc1
    global_load_dwordx4 v[248:251], v1, s[64:65] offset:3072 sc1
    global_load_dwordx4 v[252:255], v1, s[66:67] offset:3072 sc1
    s_waitcnt lgkmcnt(0)
    s_waitcnt vmcnt(14)
    v_mfma_f32_32x32x16_bf16 v[16:31], v[128:131], v[80:83], v[16:31]
    v_mfma_f32_32x32x16_bf16 v[32:47], v[132:135], v[80:83], v[32:47]
    v_mfma_f32_32x32x16_bf16 v[48:63], v[128:131], v[84:87], v[48:63]
    v_mfma_f32_32x32x16_bf16 v[64:79], v[132:135], v[84:87], v[64:79]
    s_waitcnt vmcnt(12)
    v_mfma_f32_32x32x16_bf16 v[16:31], v[136:139], v[88:91], v[16:31]
    v_mfma_f32_32x32x16_bf16 v[32:47], v[140:143], v[88:91], v[32:47]
    v_mfma_f32_32x32x16_bf16 v[48:63], v[136:139], v[92:95], v[48:63]
    v_mfma_f32_32x32x16_bf16 v[64:79], v[140:143], v[92:95], v[64:79]
    s_waitcnt vmcnt(10)
    v_mfma_f32_32x32x16_bf16 v[16:31], v[144:147], v[96:99], v[16:31]
    v_mfma_f32_32x32x16_bf16 v[32:47], v[148:151], v[96:99], v[32:47]
    v_mfma_f32_32x32x16_bf16 v[48:63], v[144:147], v[100:103], v[48:63]
    v_mfma_f32_32x32x16_bf16 v[64:79], v[148:151], v[100:103], v[64:79]
    s_waitcnt vmcnt(8)
    v_mfma_f32_32x32x16_bf16 v[16:31], v[152:155], v[104:107], v[16:31]
    v_mfma_f32_32x32x16_bf16 v[32:47], v[156:159], v[104:107], v[32:47]
    v_mfma_f32_32x32x16_bf16 v[48:63], v[152:155], v[108:111], v[48:63]
    v_mfma_f32_32x32x16_bf16 v[64:79], v[156:159], v[108:111], v[64:79]
    s_waitcnt vmcnt(6)
    v_mfma_f32_32x32x16_bf16 v[16:31], v[160:163], v[112:115], v[16:31]
    v_mfma_f32_32x32x16_bf16 v[32:47], v[164:167], v[112:115], v[32:47]
    v_mfma_f32_32x32x16_bf16 v[48:63], v[160:163], v[116:119], v[48:63]
    v_mfma_f32_32x32x16_bf16 v[64:79], v[164:167], v[116:119], v[64:79]
    s_waitcnt vmcnt(4)
    v_mfma_f32_32x32x16_bf16 v[16:31], v[168:171], v[120:123], v[16:31]
    v_mfma_f32_32x32x16_bf16 v[32:47], v[172:175], v[120:123], v[32:47]
    v_mfma_f32_32x32x16_bf16 v[48:63], v[168:171], v[124:127], v[48:63]
    v_mfma_f32_32x32x16_bf16 v[64:79], v[172:175], v[124:127], v[64:79]
    s_waitcnt vmcnt(2)
    v_mfma_f32_32x32x16_bf16 v[16:31], v[176:179], v[240:243], v[16:31]
    v_mfma_f32_32x32x16_bf16 v[32:47], v[180:183], v[240:243], v[32:47]
    v_mfma_f32_32x32x16_bf16 v[48:63], v[176:179], v[244:247], v[48:63]
    v_mfma_f32_32x32x16_bf16 v[64:79], v[180:183], v[244:247], v[64:79]
    s_waitcnt vmcnt(0)
    v_mfma_f32_32x32x16_bf16 v[16:31], v[184:187], v[248:251], v[16:31]
    v_mfma_f32_32x32x16_bf16 v[32:47], v[188:191], v[248:251], v[32:47]
    v_mfma_f32_32x32x16_bf16 v[48:63], v[184:187], v[252:255], v[48:63]
    v_mfma_f32_32x32x16_bf16 v[64:79], v[188:191], v[252:255], v[64:79]
    s_nop 9
    ds_write_b128 v4, v[32:35] offset:0
    ds_write_b128 v4, v[36:39] offset:1024
    ds_write_b128 v4, v[40:43] offset:2048
    ds_write_b128 v4, v[44:47] offset:3072
    ds_write_b128 v4, v[48:51] offset:4096
    ds_write_b128 v4, v[52:55] offset:5120
    ds_write_b128 v4, v[56:59] offset:6144
    ds_write_b128 v4, v[60:63] offset:7168
    ds_write_b128 v4, v[64:67] offset:8192
    ds_write_b128 v4, v[68:71] offset:9216
    ds_write_b128 v4, v[72:75] offset:10240
    ds_write_b128 v4, v[76:79] offset:11264
    s_mov_b64 exec, 1
    ds_add_u32 v7, v8
    s_mov_b64 exec, -1
Y_wr:
    ds_read_b32 v3, v7
    s_waitcnt lgkmcnt(0)
    v_readfirstlane_b32 s26, v3
    s_nop 0
    s_cmp_ge_u32 s26, 4
    s_cbranch_scc1 Y_wr_d
    s_sleep 1
    s_sub_u32 s98, s98, 1
    s_cmp_gt_i32 s98, 0
    s_cbranch_scc1 Y_wr
Y_wr_d:
    ds_read_b128 v[80:83], v10 offset:0
    ds_read_b128 v[84:87], v10 offset:1024
    ds_read_b128 v[88:91], v10 offset:2048
    ds_read_b128 v[92:95], v10 offset:3072
    ds_read_b128 v[96:99], v11 offset:4096
    ds_read_b128 v[100:103], v11 offset:5120
    ds_read_b128 v[104:107], v11 offset:6144
    ds_read_b128 v[108:111], v11 offset:7168
    ds_read_b128 v[112:115], v12 offset:8192
    ds_read_b128 v[116:119], v12 offset:9216
    ds_read_b128 v[120:123], v12 offset:10240
    ds_read_b128 v[124:127], v12 offset:11264
    s_waitcnt lgkmcnt(8)
    v_add_f32 v16, v16, v80
    v_add_f32 v17, v17, v81
    v_add_f32 v18, v18, v82
    v_add_f32 v19, v19, v83
    v_add_f32 v20, v20, v84
    v_add_f32 v21, v21, v85
    v_add_f32 v22, v22, v86
    v_add_f32 v23, v23, v87
    v_add_f32 v24, v24, v88
    v_add_f32 v25, v25, v89
    v_add_f32 v26, v26, v90
    v_add_f32 v27, v27, v91
    v_add_f32 v28, v28, v92
    v_add_f32 v29, v29, v93
    v_add_f32 v30, v30, v94
    v_add_f32 v31, v31, v95
    s_waitcnt lgkmcnt(4)
    v_add_f32 v16, v16, v96
    v_add_f32 v17, v17, v97
    v_add_f32 v18, v18, v98
    v_add_f32 v19, v19, v99
    v_add_f32 v20, v20, v100
    v_add_f32 v21, v21, v101
    v_add_f32 v22, v22, v102
    v_add_f32 v23, v23, v103
    v_add_f32 v24, v24, v104
    v_add_f32 v25, v25, v105
    v_add_f32 v26, v26, v106
    v_add_f32 v27, v27, v107
    v_add_f32 v28, v28, v108
    v_add_f32 v29, v29, v109
    v_add_f32 v30, v30, v110
    v_add_f32 v31, v31, v111
    s_waitcnt lgkmcnt(0)
    v_add_f32 v16, v16, v112
    v_add_f32 v17, v17, v113
    v_add_f32 v18, v18, v114
    v_add_f32 v19, v19, v115
    v_add_f32 v20, v20, v116
    v_add_f32 v21, v21, v117
    v_add_f32 v22, v22, v118
    v_add_f32 v23, v23, v119
    v_add_f32 v24, v24, v120
    v_add_f32 v25, v25, v121
    v_add_f32 v26, v26, v122
    v_add_f32 v27, v27, v123
    v_add_f32 v28, v28, v124
    v_add_f32 v29, v29, v125
    v_add_f32 v30, v30, v126
    v_add_f32 v31, v31, v127
    s_nop 1
    v_permlane32_swap_b32 v16, v20
    v_permlane32_swap_b32 v17, v21
    v_permlane32_swap_b32 v18, v22
    v_permlane32_swap_b32 v19, v23
    v_permlane32_swap_b32 v24, v28
    v_permlane32_swap_b32 v25, v29
    v_permlane32_swap_b32 v26, v30
    v_permlane32_swap_b32 v27, v31
    v_lshlrev_b32 v2, 16, v192
    v_and_b32 v3, 0xffff0000, v192
    v_add_f32 v16, v16, v2
    v_add_f32 v17, v17, v3
    v_cvt_pk_bf16_f32 v192, v16, v17
    v_lshlrev_b32 v2, 16, v193
    v_and_b32 v3, 0xffff0000, v193
    v_add_f32 v18, v18, v2
    v_add_f32 v19, v19, v3
    v_cvt_pk_bf16_f32 v193, v18, v19
    v_lshlrev_b32 v2, 16, v194
    v_and_b32 v3, 0xffff0000, v194
    v_add_f32 v20, v20, v2
    v_add_f32 v21, v21, v3
    v_cvt_pk_bf16_f32 v194, v20, v21
    v_lshlrev_b32 v2, 16, v195
    v_and_b32 v3, 0xffff0000, v195
    v_add_f32 v22, v22, v2
    v_add_f32 v23, v23, v3
    v_cvt_pk_bf16_f32 v195, v22, v23
    v_lshlrev_b32 v2, 16, v196
    v_and_b32 v3, 0xffff0000, v196
    v_add_f32 v24, v24, v2
    v_add_f32 v25, v25, v3
    v_cvt_pk_bf16_f32 v196, v24, v25
    v_lshlrev_b32 v2, 16, v197
    v_and_b32 v3, 0xffff0000, v197
    v_add_f32 v26, v26, v2
    v_add_f32 v27, v27, v3
    v_cvt_pk_bf16_f32 v197, v26, v27
    v_lshlrev_b32 v2, 16, v198
    v_and_b32 v3, 0xffff0000, v198
    v_add_f32 v28, v28, v2
    v_add_f32 v29, v29, v3
    v_cvt_pk_bf16_f32 v198, v28, v29
    v_lshlrev_b32 v2, 16, v199
    v_and_b32 v3, 0xffff0000, v199
    v_add_f32 v30, v30, v2
    v_add_f32 v31, v31, v3
    v_cvt_pk_bf16_f32 v199, v30, v31
    global_store_dwordx4 v6, v[192:195], s[34:35]
    global_store_dwordx4 v6, v[196:199], s[34:35] offset:32
    s_or_b32 s26, s2, s13
    s_cbranch_scc1 O_end
    s_xor_b32 s27, s60, 0x5bd1e995
    s_add_u32 s27, s27, 1
    v_mov_b32 v2, 29097984
    v_mov_b32 v3, s27
    s_mov_b64 exec, 1
    global_store_dword v2, v3, s[4:5] sc1
O_end:
    s_endpgm
.section .rodata,"a"
.p2align 6
.amdhsa_kernel parallel_sum__mha_block__mixer_gmlp__prompt_kernel
  .amdhsa_next_free_vgpr 256
  .amdhsa_next_free_sgpr 100
  .amdhsa_accum_offset 256
  .amdhsa_group_segment_fixed_size 0
  .amdhsa_kernarg_size 88
  .amdhsa_user_sgpr_count 2
  .amdhsa_user_sgpr_kernarg_segment_ptr 1
  .amdhsa_system_sgpr_workgroup_id_x 1
  .amdhsa_float_denorm_mode_32 3
.end_amdhsa_kernel
```
